```python
import torch

def _softmax(x, axis=-1):
    return torch.softmax(x, dim=axis)

def _gelu(x):
    return torch.nn.functional.gelu(x, approximate='tanh')

def _silu(x):
    return torch.nn.functional.silu(x)

def _sigmoid(x):
    return torch.sigmoid(x)

def _layernorm(x, axis=-1, eps=1e-05):
    m = x.mean(dim=axis, keepdim=True)
    v = x.var(dim=axis, keepdim=True, unbiased=False)
    return (x - m) / torch.sqrt(v + eps)

def _scatter_add(tgt, idx, src, axis=0):
    return tgt.clone().index_add_(axis, idx, src)

def _segment_sum(src, seg, n):
    out = torch.zeros((n,) + src.shape[1:], dtype=src.dtype)
    return out.index_add_(0, seg, src)

def _pad(x, pw):
    flat = tuple((v for pair in reversed(pw) for v in pair))
    return torch.nn.functional.pad(x, flat)
kernel_name = 'adaLN_cond__mha_block_cached__glu_gated_geglu__decode'

def setup_inputs():

    _w = lambda a: (lambda t: t.to(torch.bfloat16) if t.is_floating_point() else t)(torch.as_tensor(a))

    def _A_setup():
        B, Sq, D = (1, 1, 640)
        H, Sk, Dh = (32, 32768, 128)
        return {'x': _w((lambda *s: torch.randn(*s, dtype=torch.bfloat16) * 0.1)(B, Sq, D)), 'k_cache': _w((lambda *s: torch.randn(*s, dtype=torch.bfloat16) * 0.8)(B, H, Sk, Dh)), 'v_cache': _w((lambda *s: torch.randn(*s, dtype=torch.bfloat16) * 3.2)(B, H, Sk, Dh)), 'wq': _w((lambda *s: torch.randn(*s, dtype=torch.bfloat16) * 0.8)(D, H * Dh) * D ** (-0.5)), 'wo': _w((lambda *s: torch.randn(*s, dtype=torch.bfloat16) * 3.2)(H * Dh, D) * (H * Dh) ** (-0.5))}
    _A_in = _A_setup()

    def _B_setup():
        B, S, Dm, Df = (1, 1, 640, 1728)
        return {'x': _w((lambda *s: torch.randn(*s, dtype=torch.bfloat16) * 0.1)(B, S, Dm)), 'w_gate': _w((lambda *s: torch.randn(*s, dtype=torch.bfloat16) * 3.2)(Dm, Df) * Dm ** (-0.5)), 'w_up': _w((lambda *s: torch.randn(*s, dtype=torch.bfloat16) * 3.2)(Dm, Df) * Dm ** (-0.5)), 'w_down': _w((lambda *s: torch.randn(*s, dtype=torch.bfloat16) * 3.2)(Df, Dm) * Df ** (-0.5))}
    _B_in = _B_setup()
    return {'A_x': _A_in['x'], 'A_k_cache': _A_in['k_cache'], 'A_v_cache': _A_in['v_cache'], 'A_wq': _A_in['wq'], 'A_wo': _A_in['wo'], 'B_x': _B_in['x'], 'B_w_gate': _B_in['w_gate'], 'B_w_up': _B_in['w_up'], 'B_w_down': _B_in['w_down'], 'c': _w((lambda *s: torch.randn(*s, dtype=torch.bfloat16) * 0.4)(1, 640) * 8.0), 'w_mod': _w((lambda *s: torch.randn(*s, dtype=torch.bfloat16) * 0.4)(640, 6 * 640) * 640 ** (-0.5) * 8.0)}

def reference(A_x, A_k_cache, A_v_cache, A_wq, A_wo, B_x, B_w_gate, B_w_up, B_w_down, c, w_mod):

    def _A_ref(x, k_cache, v_cache, wq, wo):
        B, Sq, D = x.shape
        H, Dh = (32, 128)
        q = (lambda x, *d: x.permute(*d))((x @ wq).reshape(B, Sq, H, Dh), 0, 2, 1, 3)
        scores = torch.einsum('bhqd,bhkd->bhqk', q, k_cache) * Dh ** (-0.5)
        p = _softmax(scores, axis=-1)
        o = torch.einsum('bhqk,bhkd->bhqd', p, v_cache)
        return (lambda x, *d: x.permute(*d))(o, 0, 2, 1, 3).reshape(B, Sq, H * Dh) @ wo

    def _B_ref(x, w_gate, w_up, w_down):
        g = torch.einsum('bsd,df->bsf', x, w_gate)
        u = torch.einsum('bsd,df->bsf', x, w_up)
        h = _gelu(g) * u
        return torch.einsum('bsf,fd->bsd', h, w_down)
    x = A_x
    mod = (_silu(c) @ w_mod).reshape(c.shape[0], 6, 1, -1)
    sa, ca, ga, sb, cb, gb = (mod[:, 0].clone(), mod[:, 1].clone(), mod[:, 2].clone(), mod[:, 3].clone(), mod[:, 4].clone(), mod[:, 5].clone())
    h = _layernorm(x, axis=-1) * (1 + ca) + sa
    x = x + ga * _A_ref(h, A_k_cache, A_v_cache, A_wq, A_wo)
    h = _layernorm(x, axis=-1) * (1 + cb) + sb
    x = x + gb * _B_ref(h, B_w_gate, B_w_up, B_w_down)
    return x
```

```asm
; @launch grid=(256,1,1) block=(512,1,1) lds=111872
.amdgcn_target "amdgcn-amd-amdhsa--gfx950"
.text
.globl adaLN_cond__mha_block_cached__glu_gated_geglu__decode_kernel
.p2align 8
.type adaLN_cond__mha_block_cached__glu_gated_geglu__decode_kernel,@function
adaLN_cond__mha_block_cached__glu_gated_geglu__decode_kernel:
KSTART:
    s_load_dwordx16 s[16:31], s[0:1], 0
    s_load_dwordx8 s[32:39], s[0:1], 64
    s_load_dwordx4 s[40:43], s[0:1], 96
    s_cmp_ge_u32 s2, 256
    s_cbranch_scc1 L_EXIT
    v_lshrrev_b32 v1, 6, v0
    v_and_b32 v0, 63, v0
    s_and_b32 s4, s2, 7
    v_readfirstlane_b32 s3, v1
    s_lshr_b32 s5, s2, 3
    s_mov_b32 s6, 0
    s_mov_b32 s7, s5
    s_cmp_eq_u32 s4, 0
    s_cselect_b32 s6, 3, s6
    s_and_b32 s13, s4, 5
    s_cmp_eq_u32 s13, 1
    s_cselect_b32 s6, 2, s6
    s_cmp_eq_u32 s13, 5
    s_cselect_b32 s6, 4, s6
    s_cmp_eq_u32 s4, 3
    s_cselect_b32 s13, 32, 0
    s_add_u32 s7, s7, s13
    s_cmp_eq_u32 s4, 4
    s_cselect_b32 s6, 1, s6
    s_cselect_b32 s13, 10, 0
    s_add_u32 s7, s7, s13
    s_cmp_lg_u32 s4, 2
    s_cbranch_scc1 L_R2
    s_cmp_lt_u32 s5, 22
    s_cselect_b32 s6, 3, 1
    s_cselect_b32 s13, 32, -22
    s_add_u32 s7, s7, s13
L_R2:
    s_cmp_lg_u32 s4, 6
    s_cbranch_scc1 L_R6
    s_cmp_lt_u32 s5, 18
    s_cselect_b32 s6, 1, 0
    s_add_u32 s7, s7, 42
L_R6:
    s_cmp_lt_u32 s3, 4
    s_cbranch_scc1 L_HELPER
L_STREAM:
L_STREAM_E:
    s_sub_u32 s7, s3, 4
    s_lshl_b32 s14, s5, 1
    s_add_u32 s14, s14, s4
    s_and_b32 s14, s14, 7
    v_lshrrev_b32 v6, 4, v0
    v_and_b32 v7, 3, v0
    v_lshl_add_u32 v7, v6, 2, v7
    v_lshlrev_b32 v7, 4, v7
    v_bfe_u32 v8, v0, 2, 2
    v_lshl_add_u32 v1, v8, 8, v7
    v_lshlrev_b32 v2, 4, v0
    s_mul_i32 s44, s14, 256
    s_add_u32 s44, s44, s7
    s_lshl_b32 s44, s44, 12
    s_mul_i32 s45, s14, 256
    s_add_u32 s45, s45, s7
    s_add_u32 s45, s45, 240
    s_lshl_b32 s45, s45, 12
    s_lshl_b32 s46, s5, 23
    s_waitcnt lgkmcnt(0)
    s_mov_b32 s8, s42
    s_mov_b32 s9, s43
    s_add_u32 s24, s20, s46
    s_addc_u32 s25, s21, 0
    s_add_u32 s20, s18, s46
    s_addc_u32 s21, s19, 0
    s_mov_b32 s22, 0x800000
    s_mov_b32 s23, 0x20000
    s_mov_b32 s26, 0x800000
    s_mov_b32 s27, 0x20000
    s_mov_b32 s28, s44
    s_mov_b32 s29, s7
    s_mov_b32 s30, s44
    s_mov_b32 s31, s45
    s_load_dword s12, s[8:9], 0
    s_cmp_eq_u32 s6, 1
    s_cbranch_scc0 L_ST_GO_E
    s_barrier
L_ST_GO_E:
    buffer_load_dwordx4 v[64:67], v1, s[20:23], s28 offen offset:0 nt
    buffer_load_dwordx4 v[68:71], v1, s[20:23], s28 offen offset:1024 nt
    buffer_load_dwordx4 v[72:75], v1, s[20:23], s28 offen offset:2048 nt
    buffer_load_dwordx4 v[76:79], v1, s[20:23], s28 offen offset:3072 nt
    s_add_u32 s28, s28, 16384
    buffer_load_dwordx4 v[80:83], v1, s[20:23], s28 offen offset:0 nt
    buffer_load_dwordx4 v[84:87], v1, s[20:23], s28 offen offset:1024 nt
    buffer_load_dwordx4 v[88:91], v1, s[20:23], s28 offen offset:2048 nt
    buffer_load_dwordx4 v[92:95], v1, s[20:23], s28 offen offset:3072 nt
    s_add_u32 s28, s28, 16384
    s_mov_b32 s10, 6291456
    s_mov_b32 s11, 0x20000
    v_lshrrev_b32 v6, 2, v0
    v_lshrrev_b32 v4, 4, v0
    v_lshlrev_b32 v4, 4, v4
    v_bfe_u32 v7, v0, 3, 1
    v_lshl_add_u32 v51, v7, 3, v4
    v_and_b32 v7, 15, v0
    v_lshl_add_u32 v4, v7, 6, v4
    v_bfe_u32 v7, v0, 2, 1
    v_lshlrev_b32 v7, 4, v7
    v_sub_u32 v54, 16, v7
    s_mul_i32 s34, s29, 4096
    s_add_u32 s34, s34, 0
    v_lshl_add_u32 v3, v6, 2, s34
    v_mov_b32 v5, 0xff800000
    s_cmp_eq_u32 s6, 2
    s_cbranch_scc0 L_ST_GO2_E
    s_barrier
L_ST_GO2_E:
    s_sub_u32 s15, s6, 1
    s_cmp_lt_u32 s15, 2
    s_cselect_b32 s15, 1, 0
    v_mov_b32 v9, 29424
    s_cmp_eq_u32 s15, 0
    s_cbranch_scc1 L_PKW_1
    ds_read_b32 v8, v9
    s_waitcnt lgkmcnt(0)
    v_readfirstlane_b32 s13, v8
    s_cmp_eq_u32 s13, 0x51525359
    s_cbranch_scc1 L_PKS_2
L_PKW_1:
    s_waitcnt vmcnt(4)
L_PKS_2:
    buffer_load_dwordx4 v[96:99], v1, s[20:23], s28 offen offset:0 nt
    buffer_load_dwordx4 v[100:103], v1, s[20:23], s28 offen offset:1024 nt
    buffer_load_dwordx4 v[104:107], v1, s[20:23], s28 offen offset:2048 nt
    buffer_load_dwordx4 v[108:111], v1, s[20:23], s28 offen offset:3072 nt
    s_add_u32 s28, s28, 16384
    s_cmp_eq_u32 s15, 0
    s_cbranch_scc1 L_PKW_3
    ds_read_b32 v8, v9
    s_waitcnt lgkmcnt(0)
    v_readfirstlane_b32 s13, v8
    s_cmp_eq_u32 s13, 0x51525359
    s_cbranch_scc1 L_PKS_4
L_PKW_3:
    s_waitcnt vmcnt(4)
L_PKS_4:
    buffer_load_dwordx4 v[112:115], v1, s[20:23], s28 offen offset:0 nt
    buffer_load_dwordx4 v[116:119], v1, s[20:23], s28 offen offset:1024 nt
    buffer_load_dwordx4 v[120:123], v1, s[20:23], s28 offen offset:2048 nt
    buffer_load_dwordx4 v[124:127], v1, s[20:23], s28 offen offset:3072 nt
    s_add_u32 s28, s28, 16384
    s_cmp_eq_u32 s15, 0
    s_cbranch_scc1 L_PKW_5
    ds_read_b32 v8, v9
    s_waitcnt lgkmcnt(0)
    v_readfirstlane_b32 s13, v8
    s_cmp_eq_u32 s13, 0x51525359
    s_cbranch_scc1 L_PKS_6
L_PKW_5:
    s_waitcnt vmcnt(4)
L_PKS_6:
    buffer_load_dwordx4 v[128:131], v1, s[20:23], s28 offen offset:0 nt
    buffer_load_dwordx4 v[132:135], v1, s[20:23], s28 offen offset:1024 nt
    buffer_load_dwordx4 v[136:139], v1, s[20:23], s28 offen offset:2048 nt
    buffer_load_dwordx4 v[140:143], v1, s[20:23], s28 offen offset:3072 nt
    s_add_u32 s28, s28, 16384
    s_cmp_eq_u32 s15, 0
    s_cbranch_scc1 L_PKW_7
    ds_read_b32 v8, v9
    s_waitcnt lgkmcnt(0)
    v_readfirstlane_b32 s13, v8
    s_cmp_eq_u32 s13, 0x51525359
    s_cbranch_scc1 L_PKS_8
L_PKW_7:
    s_waitcnt vmcnt(4)
L_PKS_8:
    buffer_load_dwordx4 v[144:147], v1, s[20:23], s28 offen offset:0 nt
    buffer_load_dwordx4 v[148:151], v1, s[20:23], s28 offen offset:1024 nt
    buffer_load_dwordx4 v[152:155], v1, s[20:23], s28 offen offset:2048 nt
    buffer_load_dwordx4 v[156:159], v1, s[20:23], s28 offen offset:3072 nt
    s_add_u32 s28, s28, 16384
    s_cmp_eq_u32 s15, 0
    s_cbranch_scc1 L_PKW_9
    ds_read_b32 v8, v9
    s_waitcnt lgkmcnt(0)
    v_readfirstlane_b32 s13, v8
    s_cmp_eq_u32 s13, 0x51525359
    s_cbranch_scc1 L_PKS_10
L_PKW_9:
    s_waitcnt vmcnt(4)
L_PKS_10:
    buffer_load_dwordx4 v[160:163], v1, s[20:23], s28 offen offset:0 nt
    buffer_load_dwordx4 v[164:167], v1, s[20:23], s28 offen offset:1024 nt
    buffer_load_dwordx4 v[168:171], v1, s[20:23], s28 offen offset:2048 nt
    buffer_load_dwordx4 v[172:175], v1, s[20:23], s28 offen offset:3072 nt
    s_add_u32 s28, s28, 16384
    s_cmp_eq_u32 s15, 0
    s_cbranch_scc1 L_PKW_11
    ds_read_b32 v8, v9
    s_waitcnt lgkmcnt(0)
    v_readfirstlane_b32 s13, v8
    s_cmp_eq_u32 s13, 0x51525359
    s_cbranch_scc1 L_PKS_12
L_PKW_11:
    s_waitcnt vmcnt(4)
L_PKS_12:
    buffer_load_dwordx4 v[176:179], v1, s[20:23], s28 offen offset:0 nt
    buffer_load_dwordx4 v[180:183], v1, s[20:23], s28 offen offset:1024 nt
    buffer_load_dwordx4 v[184:187], v1, s[20:23], s28 offen offset:2048 nt
    buffer_load_dwordx4 v[188:191], v1, s[20:23], s28 offen offset:3072 nt
    s_add_u32 s28, s28, 16384
    s_cmp_eq_u32 s15, 0
    s_cbranch_scc1 L_PKW_13
    ds_read_b32 v8, v9
    s_waitcnt lgkmcnt(0)
    v_readfirstlane_b32 s13, v8
    s_cmp_eq_u32 s13, 0x51525359
    s_cbranch_scc1 L_PKS_14
L_PKW_13:
    s_waitcnt vmcnt(4)
L_PKS_14:
    buffer_load_dwordx4 v[192:195], v1, s[20:23], s28 offen offset:0 nt
    buffer_load_dwordx4 v[196:199], v1, s[20:23], s28 offen offset:1024 nt
    buffer_load_dwordx4 v[200:203], v1, s[20:23], s28 offen offset:2048 nt
    buffer_load_dwordx4 v[204:207], v1, s[20:23], s28 offen offset:3072 nt
    s_add_u32 s28, s28, 16384
    s_cmp_eq_u32 s15, 0
    s_cbranch_scc1 L_PKW_15
    ds_read_b32 v8, v9
    s_waitcnt lgkmcnt(0)
    v_readfirstlane_b32 s13, v8
    s_cmp_eq_u32 s13, 0x51525359
    s_cbranch_scc1 L_PKS_16
L_PKW_15:
    s_waitcnt vmcnt(4)
L_PKS_16:
    buffer_load_dwordx4 v[208:211], v1, s[20:23], s28 offen offset:0 nt
    buffer_load_dwordx4 v[212:215], v1, s[20:23], s28 offen offset:1024 nt
    buffer_load_dwordx4 v[216:219], v1, s[20:23], s28 offen offset:2048 nt
    buffer_load_dwordx4 v[220:223], v1, s[20:23], s28 offen offset:3072 nt
    s_add_u32 s28, s28, 16384
    s_cmp_eq_u32 s15, 0
    s_cbranch_scc1 L_PKW_17
    ds_read_b32 v8, v9
    s_waitcnt lgkmcnt(0)
    v_readfirstlane_b32 s13, v8
    s_cmp_eq_u32 s13, 0x51525359
    s_cbranch_scc1 L_PKS_18
L_PKW_17:
    s_waitcnt vmcnt(4)
L_PKS_18:
    buffer_load_dwordx4 v[224:227], v1, s[20:23], s28 offen offset:0 nt
    buffer_load_dwordx4 v[228:231], v1, s[20:23], s28 offen offset:1024 nt
    buffer_load_dwordx4 v[232:235], v1, s[20:23], s28 offen offset:2048 nt
    buffer_load_dwordx4 v[236:239], v1, s[20:23], s28 offen offset:3072 nt
    s_add_u32 s28, s28, 16384
    s_cmp_eq_u32 s15, 0
    s_cbranch_scc1 L_PKW_19
    ds_read_b32 v8, v9
    s_waitcnt lgkmcnt(0)
    v_readfirstlane_b32 s13, v8
    s_cmp_eq_u32 s13, 0x51525359
    s_cbranch_scc1 L_PKS_20
L_PKW_19:
    s_waitcnt vmcnt(4)
L_PKS_20:
    buffer_load_dwordx4 v[240:243], v1, s[20:23], s28 offen offset:0 nt
    buffer_load_dwordx4 v[244:247], v1, s[20:23], s28 offen offset:1024 nt
    buffer_load_dwordx4 v[248:251], v1, s[20:23], s28 offen offset:2048 nt
    buffer_load_dwordx4 v[252:255], v1, s[20:23], s28 offen offset:3072 nt
    s_add_u32 s28, s28, 16384
    v_and_b32 v6, 3, v0
    v_cmp_eq_u32 s[32:33], 1, v6
    v_cmp_eq_u32 s[34:35], 2, v6
    v_cmp_eq_u32 s[36:37], 3, v6
    s_mov_b32 s56, 0xf000f
    s_mov_b32 s57, 0xf000f
    s_waitcnt lgkmcnt(0)
    s_mul_i32 s12, s12, 1664525
    s_add_u32 s12, s12, 1013904223
    s_mul_i32 s39, s5, 128
    s_lshr_b32 s40, s14, 1
    s_mul_i32 s40, s40, 32
    s_add_u32 s39, s39, s40
    s_and_b32 s40, s14, 1
    s_mul_i32 s40, s40, 16
    s_add_u32 s39, s39, s40
    s_mul_i32 s40, s29, 4
    s_add_u32 s39, s39, s40
    s_lshl_b32 s39, s39, 6
    s_add_u32 s39, s39, 2097152
    v_mov_b32 v57, s12
    v_mov_b32 v59, s12
    s_barrier
    v_lshrrev_b32 v6, 4, v0
    v_and_b32 v7, 3, v0
    v_lshl_add_u32 v6, v6, 2, v7
    v_lshlrev_b32 v6, 4, v6
    ds_read_b128 v[8:11], v6 offset:16384
    v_bfe_u32 v7, v0, 2, 2
    s_waitcnt lgkmcnt(0)
    v_cmp_eq_u32 vcc, 0, v7
    s_nop 1
    v_cndmask_b32 v16, 0, v8, vcc
    v_cndmask_b32 v17, 0, v9, vcc
    v_cndmask_b32 v18, 0, v10, vcc
    v_cndmask_b32 v19, 0, v11, vcc
    v_cmp_eq_u32 vcc, 1, v7
    s_nop 1
    v_cndmask_b32 v20, 0, v8, vcc
    v_cndmask_b32 v21, 0, v9, vcc
    v_cndmask_b32 v22, 0, v10, vcc
    v_cndmask_b32 v23, 0, v11, vcc
    v_cmp_eq_u32 vcc, 2, v7
    s_nop 1
    v_cndmask_b32 v24, 0, v8, vcc
    v_cndmask_b32 v25, 0, v9, vcc
    v_cndmask_b32 v26, 0, v10, vcc
    v_cndmask_b32 v27, 0, v11, vcc
    v_cmp_eq_u32 vcc, 3, v7
    s_nop 1
    v_cndmask_b32 v28, 0, v8, vcc
    v_cndmask_b32 v29, 0, v9, vcc
    v_cndmask_b32 v30, 0, v10, vcc
    v_cndmask_b32 v31, 0, v11, vcc
    s_mov_b32 s55, 0
    s_mov_b32 s58, 12
L_KLOOP_E:
    s_waitcnt vmcnt(44)
    v_mfma_f32_16x16x32_bf16 v[12:15], v[64:67], v[16:19], 0
    v_mfma_f32_16x16x32_bf16 v[12:15], v[68:71], v[20:23], v[12:15]
    v_mfma_f32_16x16x32_bf16 v[12:15], v[72:75], v[24:27], v[12:15]
    v_mfma_f32_16x16x32_bf16 v[12:15], v[76:79], v[28:31], v[12:15]
    s_waitcnt vmcnt(12)
    s_cmp_eq_u32 s58, 60
    s_cselect_b32 s28, s31, s28
    s_add_u32 s58, s58, 1
    buffer_load_dwordx4 v[64:67], v1, s[20:23], s28 offen offset:0 nt
    buffer_load_dwordx4 v[68:71], v1, s[20:23], s28 offen offset:1024 nt
    buffer_load_dwordx4 v[72:75], v1, s[20:23], s28 offen offset:2048 nt
    buffer_load_dwordx4 v[76:79], v1, s[20:23], s28 offen offset:3072 nt
    s_add_u32 s28, s28, 16384
    v_cndmask_b32_e64 v6, v12, v13, s[32:33]
    v_cndmask_b32_e64 v6, v6, v14, s[34:35]
    v_cndmask_b32_e64 v6, v6, v15, s[36:37]
    s_nop 1
    v_add_f32_dpp v6, v6, v6 quad_perm:[1,0,3,2] row_mask:0xf bank_mask:0xf
    s_nop 1
    v_add_f32_dpp v6, v6, v6 quad_perm:[2,3,0,1] row_mask:0xf bank_mask:0xf
    v_cvt_pk_bf16_f32 v7, v6, v6
    v_lshlrev_b32 v7, 16, v7
    v_mul_f32 v7, 0x3db504f3, v7
    v_cvt_pk_bf16_f32 v7, v7, v7
    v_and_b32 v52, 0xffff0000, v7
    v_max_f32 v5, v5, v52
    ds_write_b32 v3, v52 offset:0
    s_waitcnt vmcnt(44)
    v_mfma_f32_16x16x32_bf16 v[12:15], v[80:83], v[16:19], 0
    v_mfma_f32_16x16x32_bf16 v[12:15], v[84:87], v[20:23], v[12:15]
    v_mfma_f32_16x16x32_bf16 v[12:15], v[88:91], v[24:27], v[12:15]
    v_mfma_f32_16x16x32_bf16 v[12:15], v[92:95], v[28:31], v[12:15]
    s_waitcnt vmcnt(12)
    s_cmp_eq_u32 s58, 60
    s_cselect_b32 s28, s31, s28
    s_add_u32 s58, s58, 1
    buffer_load_dwordx4 v[80:83], v1, s[20:23], s28 offen offset:0 nt
    buffer_load_dwordx4 v[84:87], v1, s[20:23], s28 offen offset:1024 nt
    buffer_load_dwordx4 v[88:91], v1, s[20:23], s28 offen offset:2048 nt
    buffer_load_dwordx4 v[92:95], v1, s[20:23], s28 offen offset:3072 nt
    s_add_u32 s28, s28, 16384
    v_cndmask_b32_e64 v6, v12, v13, s[32:33]
    v_cndmask_b32_e64 v6, v6, v14, s[34:35]
    v_cndmask_b32_e64 v6, v6, v15, s[36:37]
    s_nop 1
    v_add_f32_dpp v6, v6, v6 quad_perm:[1,0,3,2] row_mask:0xf bank_mask:0xf
    s_nop 1
    v_add_f32_dpp v6, v6, v6 quad_perm:[2,3,0,1] row_mask:0xf bank_mask:0xf
    v_cvt_pk_bf16_f32 v7, v6, v6
    v_lshlrev_b32 v7, 16, v7
    v_mul_f32 v7, 0x3db504f3, v7
    v_cvt_pk_bf16_f32 v7, v7, v7
    v_and_b32 v52, 0xffff0000, v7
    v_max_f32 v5, v5, v52
    ds_write_b32 v3, v52 offset:64
    s_waitcnt vmcnt(44)
    v_mfma_f32_16x16x32_bf16 v[12:15], v[96:99], v[16:19], 0
    v_mfma_f32_16x16x32_bf16 v[12:15], v[100:103], v[20:23], v[12:15]
    v_mfma_f32_16x16x32_bf16 v[12:15], v[104:107], v[24:27], v[12:15]
    v_mfma_f32_16x16x32_bf16 v[12:15], v[108:111], v[28:31], v[12:15]
    s_waitcnt vmcnt(12)
    s_cmp_eq_u32 s58, 60
    s_cselect_b32 s28, s31, s28
    s_add_u32 s58, s58, 1
    buffer_load_dwordx4 v[96:99], v1, s[20:23], s28 offen offset:0 nt
    buffer_load_dwordx4 v[100:103], v1, s[20:23], s28 offen offset:1024 nt
    buffer_load_dwordx4 v[104:107], v1, s[20:23], s28 offen offset:2048 nt
    buffer_load_dwordx4 v[108:111], v1, s[20:23], s28 offen offset:3072 nt
    s_add_u32 s28, s28, 16384
    v_cndmask_b32_e64 v6, v12, v13, s[32:33]
    v_cndmask_b32_e64 v6, v6, v14, s[34:35]
    v_cndmask_b32_e64 v6, v6, v15, s[36:37]
    s_nop 1
    v_add_f32_dpp v6, v6, v6 quad_perm:[1,0,3,2] row_mask:0xf bank_mask:0xf
    s_nop 1
    v_add_f32_dpp v6, v6, v6 quad_perm:[2,3,0,1] row_mask:0xf bank_mask:0xf
    v_cvt_pk_bf16_f32 v7, v6, v6
    v_lshlrev_b32 v7, 16, v7
    v_mul_f32 v7, 0x3db504f3, v7
    v_cvt_pk_bf16_f32 v7, v7, v7
    v_and_b32 v52, 0xffff0000, v7
    v_max_f32 v5, v5, v52
    ds_write_b32 v3, v52 offset:128
    s_waitcnt vmcnt(44)
    v_mfma_f32_16x16x32_bf16 v[12:15], v[112:115], v[16:19], 0
    v_mfma_f32_16x16x32_bf16 v[12:15], v[116:119], v[20:23], v[12:15]
    v_mfma_f32_16x16x32_bf16 v[12:15], v[120:123], v[24:27], v[12:15]
    v_mfma_f32_16x16x32_bf16 v[12:15], v[124:127], v[28:31], v[12:15]
    s_waitcnt vmcnt(12)
    s_cmp_eq_u32 s58, 60
    s_cselect_b32 s28, s31, s28
    s_add_u32 s58, s58, 1
    buffer_load_dwordx4 v[112:115], v1, s[20:23], s28 offen offset:0 nt
    buffer_load_dwordx4 v[116:119], v1, s[20:23], s28 offen offset:1024 nt
    buffer_load_dwordx4 v[120:123], v1, s[20:23], s28 offen offset:2048 nt
    buffer_load_dwordx4 v[124:127], v1, s[20:23], s28 offen offset:3072 nt
    s_add_u32 s28, s28, 16384
    v_cndmask_b32_e64 v6, v12, v13, s[32:33]
    v_cndmask_b32_e64 v6, v6, v14, s[34:35]
    v_cndmask_b32_e64 v6, v6, v15, s[36:37]
    s_nop 1
    v_add_f32_dpp v6, v6, v6 quad_perm:[1,0,3,2] row_mask:0xf bank_mask:0xf
    s_nop 1
    v_add_f32_dpp v6, v6, v6 quad_perm:[2,3,0,1] row_mask:0xf bank_mask:0xf
    v_cvt_pk_bf16_f32 v7, v6, v6
    v_lshlrev_b32 v7, 16, v7
    v_mul_f32 v7, 0x3db504f3, v7
    v_cvt_pk_bf16_f32 v7, v7, v7
    v_and_b32 v52, 0xffff0000, v7
    v_max_f32 v5, v5, v52
    ds_write_b32 v3, v52 offset:192
    s_waitcnt vmcnt(44)
    v_mfma_f32_16x16x32_bf16 v[12:15], v[128:131], v[16:19], 0
    v_mfma_f32_16x16x32_bf16 v[12:15], v[132:135], v[20:23], v[12:15]
    v_mfma_f32_16x16x32_bf16 v[12:15], v[136:139], v[24:27], v[12:15]
    v_mfma_f32_16x16x32_bf16 v[12:15], v[140:143], v[28:31], v[12:15]
    s_waitcnt vmcnt(12)
    s_cmp_eq_u32 s58, 60
    s_cselect_b32 s28, s31, s28
    s_add_u32 s58, s58, 1
    buffer_load_dwordx4 v[128:131], v1, s[20:23], s28 offen offset:0 nt
    buffer_load_dwordx4 v[132:135], v1, s[20:23], s28 offen offset:1024 nt
    buffer_load_dwordx4 v[136:139], v1, s[20:23], s28 offen offset:2048 nt
    buffer_load_dwordx4 v[140:143], v1, s[20:23], s28 offen offset:3072 nt
    s_add_u32 s28, s28, 16384
    v_cndmask_b32_e64 v6, v12, v13, s[32:33]
    v_cndmask_b32_e64 v6, v6, v14, s[34:35]
    v_cndmask_b32_e64 v6, v6, v15, s[36:37]
    s_nop 1
    v_add_f32_dpp v6, v6, v6 quad_perm:[1,0,3,2] row_mask:0xf bank_mask:0xf
    s_nop 1
    v_add_f32_dpp v6, v6, v6 quad_perm:[2,3,0,1] row_mask:0xf bank_mask:0xf
    v_cvt_pk_bf16_f32 v7, v6, v6
    v_lshlrev_b32 v7, 16, v7
    v_mul_f32 v7, 0x3db504f3, v7
    v_cvt_pk_bf16_f32 v7, v7, v7
    v_and_b32 v52, 0xffff0000, v7
    v_max_f32 v5, v5, v52
    ds_write_b32 v3, v52 offset:256
    s_waitcnt vmcnt(44)
    v_mfma_f32_16x16x32_bf16 v[12:15], v[144:147], v[16:19], 0
    v_mfma_f32_16x16x32_bf16 v[12:15], v[148:151], v[20:23], v[12:15]
    v_mfma_f32_16x16x32_bf16 v[12:15], v[152:155], v[24:27], v[12:15]
    v_mfma_f32_16x16x32_bf16 v[12:15], v[156:159], v[28:31], v[12:15]
    s_waitcnt vmcnt(12)
    s_cmp_eq_u32 s58, 60
    s_cselect_b32 s28, s31, s28
    s_add_u32 s58, s58, 1
    buffer_load_dwordx4 v[144:147], v1, s[20:23], s28 offen offset:0 nt
    buffer_load_dwordx4 v[148:151], v1, s[20:23], s28 offen offset:1024 nt
    buffer_load_dwordx4 v[152:155], v1, s[20:23], s28 offen offset:2048 nt
    buffer_load_dwordx4 v[156:159], v1, s[20:23], s28 offen offset:3072 nt
    s_add_u32 s28, s28, 16384
    v_cndmask_b32_e64 v6, v12, v13, s[32:33]
    v_cndmask_b32_e64 v6, v6, v14, s[34:35]
    v_cndmask_b32_e64 v6, v6, v15, s[36:37]
    s_nop 1
    v_add_f32_dpp v6, v6, v6 quad_perm:[1,0,3,2] row_mask:0xf bank_mask:0xf
    s_nop 1
    v_add_f32_dpp v6, v6, v6 quad_perm:[2,3,0,1] row_mask:0xf bank_mask:0xf
    v_cvt_pk_bf16_f32 v7, v6, v6
    v_lshlrev_b32 v7, 16, v7
    v_mul_f32 v7, 0x3db504f3, v7
    v_cvt_pk_bf16_f32 v7, v7, v7
    v_and_b32 v52, 0xffff0000, v7
    v_max_f32 v5, v5, v52
    ds_write_b32 v3, v52 offset:320
    s_waitcnt vmcnt(44)
    v_mfma_f32_16x16x32_bf16 v[12:15], v[160:163], v[16:19], 0
    v_mfma_f32_16x16x32_bf16 v[12:15], v[164:167], v[20:23], v[12:15]
    v_mfma_f32_16x16x32_bf16 v[12:15], v[168:171], v[24:27], v[12:15]
    v_mfma_f32_16x16x32_bf16 v[12:15], v[172:175], v[28:31], v[12:15]
    s_waitcnt vmcnt(12)
    s_cmp_eq_u32 s58, 60
    s_cselect_b32 s28, s31, s28
    s_add_u32 s58, s58, 1
    buffer_load_dwordx4 v[160:163], v1, s[20:23], s28 offen offset:0 nt
    buffer_load_dwordx4 v[164:167], v1, s[20:23], s28 offen offset:1024 nt
    buffer_load_dwordx4 v[168:171], v1, s[20:23], s28 offen offset:2048 nt
    buffer_load_dwordx4 v[172:175], v1, s[20:23], s28 offen offset:3072 nt
    s_add_u32 s28, s28, 16384
    v_cndmask_b32_e64 v6, v12, v13, s[32:33]
    v_cndmask_b32_e64 v6, v6, v14, s[34:35]
    v_cndmask_b32_e64 v6, v6, v15, s[36:37]
    s_nop 1
    v_add_f32_dpp v6, v6, v6 quad_perm:[1,0,3,2] row_mask:0xf bank_mask:0xf
    s_nop 1
    v_add_f32_dpp v6, v6, v6 quad_perm:[2,3,0,1] row_mask:0xf bank_mask:0xf
    v_cvt_pk_bf16_f32 v7, v6, v6
    v_lshlrev_b32 v7, 16, v7
    v_mul_f32 v7, 0x3db504f3, v7
    v_cvt_pk_bf16_f32 v7, v7, v7
    v_and_b32 v52, 0xffff0000, v7
    v_max_f32 v5, v5, v52
    ds_write_b32 v3, v52 offset:384
    s_waitcnt vmcnt(44)
    v_mfma_f32_16x16x32_bf16 v[12:15], v[176:179], v[16:19], 0
    v_mfma_f32_16x16x32_bf16 v[12:15], v[180:183], v[20:23], v[12:15]
    v_mfma_f32_16x16x32_bf16 v[12:15], v[184:187], v[24:27], v[12:15]
    v_mfma_f32_16x16x32_bf16 v[12:15], v[188:191], v[28:31], v[12:15]
    s_waitcnt vmcnt(12)
    s_cmp_eq_u32 s58, 60
    s_cselect_b32 s28, s31, s28
    s_add_u32 s58, s58, 1
    buffer_load_dwordx4 v[176:179], v1, s[20:23], s28 offen offset:0 nt
    buffer_load_dwordx4 v[180:183], v1, s[20:23], s28 offen offset:1024 nt
    buffer_load_dwordx4 v[184:187], v1, s[20:23], s28 offen offset:2048 nt
    buffer_load_dwordx4 v[188:191], v1, s[20:23], s28 offen offset:3072 nt
    s_add_u32 s28, s28, 16384
    v_cndmask_b32_e64 v6, v12, v13, s[32:33]
    v_cndmask_b32_e64 v6, v6, v14, s[34:35]
    v_cndmask_b32_e64 v6, v6, v15, s[36:37]
    s_nop 1
    v_add_f32_dpp v6, v6, v6 quad_perm:[1,0,3,2] row_mask:0xf bank_mask:0xf
    s_nop 1
    v_add_f32_dpp v6, v6, v6 quad_perm:[2,3,0,1] row_mask:0xf bank_mask:0xf
    v_cvt_pk_bf16_f32 v7, v6, v6
    v_lshlrev_b32 v7, 16, v7
    v_mul_f32 v7, 0x3db504f3, v7
    v_cvt_pk_bf16_f32 v7, v7, v7
    v_and_b32 v52, 0xffff0000, v7
    v_max_f32 v5, v5, v52
    ds_write_b32 v3, v52 offset:448
    s_waitcnt vmcnt(44)
    v_mfma_f32_16x16x32_bf16 v[12:15], v[192:195], v[16:19], 0
    v_mfma_f32_16x16x32_bf16 v[12:15], v[196:199], v[20:23], v[12:15]
    v_mfma_f32_16x16x32_bf16 v[12:15], v[200:203], v[24:27], v[12:15]
    v_mfma_f32_16x16x32_bf16 v[12:15], v[204:207], v[28:31], v[12:15]
    s_waitcnt vmcnt(12)
    s_cmp_eq_u32 s58, 60
    s_cselect_b32 s28, s31, s28
    s_add_u32 s58, s58, 1
    buffer_load_dwordx4 v[192:195], v1, s[20:23], s28 offen offset:0 nt
    buffer_load_dwordx4 v[196:199], v1, s[20:23], s28 offen offset:1024 nt
    buffer_load_dwordx4 v[200:203], v1, s[20:23], s28 offen offset:2048 nt
    buffer_load_dwordx4 v[204:207], v1, s[20:23], s28 offen offset:3072 nt
    s_add_u32 s28, s28, 16384
    v_cndmask_b32_e64 v6, v12, v13, s[32:33]
    v_cndmask_b32_e64 v6, v6, v14, s[34:35]
    v_cndmask_b32_e64 v6, v6, v15, s[36:37]
    s_nop 1
    v_add_f32_dpp v6, v6, v6 quad_perm:[1,0,3,2] row_mask:0xf bank_mask:0xf
    s_nop 1
    v_add_f32_dpp v6, v6, v6 quad_perm:[2,3,0,1] row_mask:0xf bank_mask:0xf
    v_cvt_pk_bf16_f32 v7, v6, v6
    v_lshlrev_b32 v7, 16, v7
    v_mul_f32 v7, 0x3db504f3, v7
    v_cvt_pk_bf16_f32 v7, v7, v7
    v_and_b32 v52, 0xffff0000, v7
    v_max_f32 v5, v5, v52
    ds_write_b32 v3, v52 offset:512
    s_waitcnt vmcnt(44)
    v_mfma_f32_16x16x32_bf16 v[12:15], v[208:211], v[16:19], 0
    v_mfma_f32_16x16x32_bf16 v[12:15], v[212:215], v[20:23], v[12:15]
    v_mfma_f32_16x16x32_bf16 v[12:15], v[216:219], v[24:27], v[12:15]
    v_mfma_f32_16x16x32_bf16 v[12:15], v[220:223], v[28:31], v[12:15]
    s_waitcnt vmcnt(12)
    s_cmp_eq_u32 s58, 60
    s_cselect_b32 s28, s31, s28
    s_add_u32 s58, s58, 1
    buffer_load_dwordx4 v[208:211], v1, s[20:23], s28 offen offset:0 nt
    buffer_load_dwordx4 v[212:215], v1, s[20:23], s28 offen offset:1024 nt
    buffer_load_dwordx4 v[216:219], v1, s[20:23], s28 offen offset:2048 nt
    buffer_load_dwordx4 v[220:223], v1, s[20:23], s28 offen offset:3072 nt
    s_add_u32 s28, s28, 16384
    v_cndmask_b32_e64 v6, v12, v13, s[32:33]
    v_cndmask_b32_e64 v6, v6, v14, s[34:35]
    v_cndmask_b32_e64 v6, v6, v15, s[36:37]
    s_nop 1
    v_add_f32_dpp v6, v6, v6 quad_perm:[1,0,3,2] row_mask:0xf bank_mask:0xf
    s_nop 1
    v_add_f32_dpp v6, v6, v6 quad_perm:[2,3,0,1] row_mask:0xf bank_mask:0xf
    v_cvt_pk_bf16_f32 v7, v6, v6
    v_lshlrev_b32 v7, 16, v7
    v_mul_f32 v7, 0x3db504f3, v7
    v_cvt_pk_bf16_f32 v7, v7, v7
    v_and_b32 v52, 0xffff0000, v7
    v_max_f32 v5, v5, v52
    ds_write_b32 v3, v52 offset:576
    s_waitcnt vmcnt(44)
    v_mfma_f32_16x16x32_bf16 v[12:15], v[224:227], v[16:19], 0
    v_mfma_f32_16x16x32_bf16 v[12:15], v[228:231], v[20:23], v[12:15]
    v_mfma_f32_16x16x32_bf16 v[12:15], v[232:235], v[24:27], v[12:15]
    v_mfma_f32_16x16x32_bf16 v[12:15], v[236:239], v[28:31], v[12:15]
    s_waitcnt vmcnt(12)
    s_cmp_eq_u32 s58, 60
    s_cselect_b32 s28, s31, s28
    s_add_u32 s58, s58, 1
    buffer_load_dwordx4 v[224:227], v1, s[20:23], s28 offen offset:0 nt
    buffer_load_dwordx4 v[228:231], v1, s[20:23], s28 offen offset:1024 nt
    buffer_load_dwordx4 v[232:235], v1, s[20:23], s28 offen offset:2048 nt
    buffer_load_dwordx4 v[236:239], v1, s[20:23], s28 offen offset:3072 nt
    s_add_u32 s28, s28, 16384
    v_cndmask_b32_e64 v6, v12, v13, s[32:33]
    v_cndmask_b32_e64 v6, v6, v14, s[34:35]
    v_cndmask_b32_e64 v6, v6, v15, s[36:37]
    s_nop 1
    v_add_f32_dpp v6, v6, v6 quad_perm:[1,0,3,2] row_mask:0xf bank_mask:0xf
    s_nop 1
    v_add_f32_dpp v6, v6, v6 quad_perm:[2,3,0,1] row_mask:0xf bank_mask:0xf
    v_cvt_pk_bf16_f32 v7, v6, v6
    v_lshlrev_b32 v7, 16, v7
    v_mul_f32 v7, 0x3db504f3, v7
    v_cvt_pk_bf16_f32 v7, v7, v7
    v_and_b32 v52, 0xffff0000, v7
    v_max_f32 v5, v5, v52
    ds_write_b32 v3, v52 offset:640
    s_waitcnt vmcnt(44)
    v_mfma_f32_16x16x32_bf16 v[12:15], v[240:243], v[16:19], 0
    v_mfma_f32_16x16x32_bf16 v[12:15], v[244:247], v[20:23], v[12:15]
    v_mfma_f32_16x16x32_bf16 v[12:15], v[248:251], v[24:27], v[12:15]
    v_mfma_f32_16x16x32_bf16 v[12:15], v[252:255], v[28:31], v[12:15]
    s_waitcnt vmcnt(12)
    s_cmp_eq_u32 s58, 60
    s_cselect_b32 s28, s31, s28
    s_add_u32 s58, s58, 1
    buffer_load_dwordx4 v[240:243], v1, s[20:23], s28 offen offset:0 nt
    buffer_load_dwordx4 v[244:247], v1, s[20:23], s28 offen offset:1024 nt
    buffer_load_dwordx4 v[248:251], v1, s[20:23], s28 offen offset:2048 nt
    buffer_load_dwordx4 v[252:255], v1, s[20:23], s28 offen offset:3072 nt
    s_add_u32 s28, s28, 16384
    v_cndmask_b32_e64 v6, v12, v13, s[32:33]
    v_cndmask_b32_e64 v6, v6, v14, s[34:35]
    v_cndmask_b32_e64 v6, v6, v15, s[36:37]
    s_nop 1
    v_add_f32_dpp v6, v6, v6 quad_perm:[1,0,3,2] row_mask:0xf bank_mask:0xf
    s_nop 1
    v_add_f32_dpp v6, v6, v6 quad_perm:[2,3,0,1] row_mask:0xf bank_mask:0xf
    v_cvt_pk_bf16_f32 v7, v6, v6
    v_lshlrev_b32 v7, 16, v7
    v_mul_f32 v7, 0x3db504f3, v7
    v_cvt_pk_bf16_f32 v7, v7, v7
    v_and_b32 v52, 0xffff0000, v7
    v_max_f32 v5, v5, v52
    ds_write_b32 v3, v52 offset:704
    v_add_u32 v3, 768, v3
    s_add_u32 s55, s55, 1
    s_cmp_lt_u32 s55, 4
    s_cbranch_scc1 L_KLOOP_E
    s_waitcnt vmcnt(44)
    v_mfma_f32_16x16x32_bf16 v[12:15], v[64:67], v[16:19], 0
    v_mfma_f32_16x16x32_bf16 v[12:15], v[68:71], v[20:23], v[12:15]
    v_mfma_f32_16x16x32_bf16 v[12:15], v[72:75], v[24:27], v[12:15]
    v_mfma_f32_16x16x32_bf16 v[12:15], v[76:79], v[28:31], v[12:15]
    s_mov_b32 s28, s31
    buffer_load_dwordx4 v[64:67], v1, s[20:23], s28 offen offset:0 nt
    buffer_load_dwordx4 v[68:71], v1, s[20:23], s28 offen offset:1024 nt
    buffer_load_dwordx4 v[72:75], v1, s[20:23], s28 offen offset:2048 nt
    buffer_load_dwordx4 v[76:79], v1, s[20:23], s28 offen offset:3072 nt
    s_add_u32 s28, s28, 16384
    s_nop 1
    v_cndmask_b32_e64 v6, v12, v13, s[32:33]
    v_cndmask_b32_e64 v6, v6, v14, s[34:35]
    v_cndmask_b32_e64 v6, v6, v15, s[36:37]
    s_nop 1
    v_add_f32_dpp v6, v6, v6 quad_perm:[1,0,3,2] row_mask:0xf bank_mask:0xf
    s_nop 1
    v_add_f32_dpp v6, v6, v6 quad_perm:[2,3,0,1] row_mask:0xf bank_mask:0xf
    v_cvt_pk_bf16_f32 v7, v6, v6
    v_lshlrev_b32 v7, 16, v7
    v_mul_f32 v7, 0x3db504f3, v7
    v_cvt_pk_bf16_f32 v7, v7, v7
    v_and_b32 v52, 0xffff0000, v7
    v_max_f32 v5, v5, v52
    ds_write_b32 v3, v52 offset:0
    s_waitcnt vmcnt(44)
    v_mfma_f32_16x16x32_bf16 v[12:15], v[80:83], v[16:19], 0
    v_mfma_f32_16x16x32_bf16 v[12:15], v[84:87], v[20:23], v[12:15]
    v_mfma_f32_16x16x32_bf16 v[12:15], v[88:91], v[24:27], v[12:15]
    v_mfma_f32_16x16x32_bf16 v[12:15], v[92:95], v[28:31], v[12:15]
    buffer_load_dwordx4 v[80:83], v1, s[20:23], s28 offen offset:0 nt
    buffer_load_dwordx4 v[84:87], v1, s[20:23], s28 offen offset:1024 nt
    buffer_load_dwordx4 v[88:91], v1, s[20:23], s28 offen offset:2048 nt
    buffer_load_dwordx4 v[92:95], v1, s[20:23], s28 offen offset:3072 nt
    s_add_u32 s28, s28, 16384
    s_nop 2
    v_cndmask_b32_e64 v6, v12, v13, s[32:33]
    v_cndmask_b32_e64 v6, v6, v14, s[34:35]
    v_cndmask_b32_e64 v6, v6, v15, s[36:37]
    s_nop 1
    v_add_f32_dpp v6, v6, v6 quad_perm:[1,0,3,2] row_mask:0xf bank_mask:0xf
    s_nop 1
    v_add_f32_dpp v6, v6, v6 quad_perm:[2,3,0,1] row_mask:0xf bank_mask:0xf
    v_cvt_pk_bf16_f32 v7, v6, v6
    v_lshlrev_b32 v7, 16, v7
    v_mul_f32 v7, 0x3db504f3, v7
    v_cvt_pk_bf16_f32 v7, v7, v7
    v_and_b32 v52, 0xffff0000, v7
    v_max_f32 v5, v5, v52
    ds_write_b32 v3, v52 offset:64
    s_waitcnt vmcnt(44)
    v_mfma_f32_16x16x32_bf16 v[12:15], v[96:99], v[16:19], 0
    v_mfma_f32_16x16x32_bf16 v[12:15], v[100:103], v[20:23], v[12:15]
    v_mfma_f32_16x16x32_bf16 v[12:15], v[104:107], v[24:27], v[12:15]
    v_mfma_f32_16x16x32_bf16 v[12:15], v[108:111], v[28:31], v[12:15]
    buffer_load_dwordx4 v[96:99], v1, s[20:23], s28 offen offset:0 nt
    buffer_load_dwordx4 v[100:103], v1, s[20:23], s28 offen offset:1024 nt
    buffer_load_dwordx4 v[104:107], v1, s[20:23], s28 offen offset:2048 nt
    buffer_load_dwordx4 v[108:111], v1, s[20:23], s28 offen offset:3072 nt
    s_add_u32 s28, s28, 16384
    s_nop 2
    v_cndmask_b32_e64 v6, v12, v13, s[32:33]
    v_cndmask_b32_e64 v6, v6, v14, s[34:35]
    v_cndmask_b32_e64 v6, v6, v15, s[36:37]
    s_nop 1
    v_add_f32_dpp v6, v6, v6 quad_perm:[1,0,3,2] row_mask:0xf bank_mask:0xf
    s_nop 1
    v_add_f32_dpp v6, v6, v6 quad_perm:[2,3,0,1] row_mask:0xf bank_mask:0xf
    v_cvt_pk_bf16_f32 v7, v6, v6
    v_lshlrev_b32 v7, 16, v7
    v_mul_f32 v7, 0x3db504f3, v7
    v_cvt_pk_bf16_f32 v7, v7, v7
    v_and_b32 v52, 0xffff0000, v7
    v_max_f32 v5, v5, v52
    ds_write_b32 v3, v52 offset:128
    s_waitcnt vmcnt(44)
    v_mfma_f32_16x16x32_bf16 v[12:15], v[112:115], v[16:19], 0
    v_mfma_f32_16x16x32_bf16 v[12:15], v[116:119], v[20:23], v[12:15]
    v_mfma_f32_16x16x32_bf16 v[12:15], v[120:123], v[24:27], v[12:15]
    v_mfma_f32_16x16x32_bf16 v[12:15], v[124:127], v[28:31], v[12:15]
    buffer_load_dwordx4 v[112:115], v1, s[20:23], s28 offen offset:0 nt
    buffer_load_dwordx4 v[116:119], v1, s[20:23], s28 offen offset:1024 nt
    buffer_load_dwordx4 v[120:123], v1, s[20:23], s28 offen offset:2048 nt
    buffer_load_dwordx4 v[124:127], v1, s[20:23], s28 offen offset:3072 nt
    s_add_u32 s28, s28, 16384
    s_nop 2
    v_cndmask_b32_e64 v6, v12, v13, s[32:33]
    v_cndmask_b32_e64 v6, v6, v14, s[34:35]
    v_cndmask_b32_e64 v6, v6, v15, s[36:37]
    s_nop 1
    v_add_f32_dpp v6, v6, v6 quad_perm:[1,0,3,2] row_mask:0xf bank_mask:0xf
    s_nop 1
    v_add_f32_dpp v6, v6, v6 quad_perm:[2,3,0,1] row_mask:0xf bank_mask:0xf
    v_cvt_pk_bf16_f32 v7, v6, v6
    v_lshlrev_b32 v7, 16, v7
    v_mul_f32 v7, 0x3db504f3, v7
    v_cvt_pk_bf16_f32 v7, v7, v7
    v_and_b32 v52, 0xffff0000, v7
    v_max_f32 v5, v5, v52
    ds_write_b32 v3, v52 offset:192
    s_waitcnt vmcnt(44)
    v_mfma_f32_16x16x32_bf16 v[12:15], v[128:131], v[16:19], 0
    v_mfma_f32_16x16x32_bf16 v[12:15], v[132:135], v[20:23], v[12:15]
    v_mfma_f32_16x16x32_bf16 v[12:15], v[136:139], v[24:27], v[12:15]
    v_mfma_f32_16x16x32_bf16 v[12:15], v[140:143], v[28:31], v[12:15]
    s_nop 7
    v_cndmask_b32_e64 v6, v12, v13, s[32:33]
    v_cndmask_b32_e64 v6, v6, v14, s[34:35]
    v_cndmask_b32_e64 v6, v6, v15, s[36:37]
    s_nop 1
    v_add_f32_dpp v6, v6, v6 quad_perm:[1,0,3,2] row_mask:0xf bank_mask:0xf
    s_nop 1
    v_add_f32_dpp v6, v6, v6 quad_perm:[2,3,0,1] row_mask:0xf bank_mask:0xf
    v_cvt_pk_bf16_f32 v7, v6, v6
    v_lshlrev_b32 v7, 16, v7
    v_mul_f32 v7, 0x3db504f3, v7
    v_cvt_pk_bf16_f32 v7, v7, v7
    v_and_b32 v52, 0xffff0000, v7
    v_max_f32 v5, v5, v52
    ds_write_b32 v3, v52 offset:256
    s_waitcnt vmcnt(40)
    v_mfma_f32_16x16x32_bf16 v[12:15], v[144:147], v[16:19], 0
    v_mfma_f32_16x16x32_bf16 v[12:15], v[148:151], v[20:23], v[12:15]
    v_mfma_f32_16x16x32_bf16 v[12:15], v[152:155], v[24:27], v[12:15]
    v_mfma_f32_16x16x32_bf16 v[12:15], v[156:159], v[28:31], v[12:15]
    s_nop 7
    v_cndmask_b32_e64 v6, v12, v13, s[32:33]
    v_cndmask_b32_e64 v6, v6, v14, s[34:35]
    v_cndmask_b32_e64 v6, v6, v15, s[36:37]
    s_nop 1
    v_add_f32_dpp v6, v6, v6 quad_perm:[1,0,3,2] row_mask:0xf bank_mask:0xf
    s_nop 1
    v_add_f32_dpp v6, v6, v6 quad_perm:[2,3,0,1] row_mask:0xf bank_mask:0xf
    v_cvt_pk_bf16_f32 v7, v6, v6
    v_lshlrev_b32 v7, 16, v7
    v_mul_f32 v7, 0x3db504f3, v7
    v_cvt_pk_bf16_f32 v7, v7, v7
    v_and_b32 v52, 0xffff0000, v7
    v_max_f32 v5, v5, v52
    ds_write_b32 v3, v52 offset:320
    s_waitcnt vmcnt(36)
    v_mfma_f32_16x16x32_bf16 v[12:15], v[160:163], v[16:19], 0
    v_mfma_f32_16x16x32_bf16 v[12:15], v[164:167], v[20:23], v[12:15]
    v_mfma_f32_16x16x32_bf16 v[12:15], v[168:171], v[24:27], v[12:15]
    v_mfma_f32_16x16x32_bf16 v[12:15], v[172:175], v[28:31], v[12:15]
    s_nop 7
    v_cndmask_b32_e64 v6, v12, v13, s[32:33]
    v_cndmask_b32_e64 v6, v6, v14, s[34:35]
    v_cndmask_b32_e64 v6, v6, v15, s[36:37]
    s_nop 1
    v_add_f32_dpp v6, v6, v6 quad_perm:[1,0,3,2] row_mask:0xf bank_mask:0xf
    s_nop 1
    v_add_f32_dpp v6, v6, v6 quad_perm:[2,3,0,1] row_mask:0xf bank_mask:0xf
    v_cvt_pk_bf16_f32 v7, v6, v6
    v_lshlrev_b32 v7, 16, v7
    v_mul_f32 v7, 0x3db504f3, v7
    v_cvt_pk_bf16_f32 v7, v7, v7
    v_and_b32 v52, 0xffff0000, v7
    v_max_f32 v5, v5, v52
    ds_write_b32 v3, v52 offset:384
    s_waitcnt vmcnt(32)
    v_mfma_f32_16x16x32_bf16 v[12:15], v[176:179], v[16:19], 0
    v_mfma_f32_16x16x32_bf16 v[12:15], v[180:183], v[20:23], v[12:15]
    v_mfma_f32_16x16x32_bf16 v[12:15], v[184:187], v[24:27], v[12:15]
    v_mfma_f32_16x16x32_bf16 v[12:15], v[188:191], v[28:31], v[12:15]
    s_nop 7
    v_cndmask_b32_e64 v6, v12, v13, s[32:33]
    v_cndmask_b32_e64 v6, v6, v14, s[34:35]
    v_cndmask_b32_e64 v6, v6, v15, s[36:37]
    s_nop 1
    v_add_f32_dpp v6, v6, v6 quad_perm:[1,0,3,2] row_mask:0xf bank_mask:0xf
    s_nop 1
    v_add_f32_dpp v6, v6, v6 quad_perm:[2,3,0,1] row_mask:0xf bank_mask:0xf
    v_cvt_pk_bf16_f32 v7, v6, v6
    v_lshlrev_b32 v7, 16, v7
    v_mul_f32 v7, 0x3db504f3, v7
    v_cvt_pk_bf16_f32 v7, v7, v7
    v_and_b32 v52, 0xffff0000, v7
    v_max_f32 v5, v5, v52
    ds_write_b32 v3, v52 offset:448
    s_waitcnt vmcnt(28)
    v_mfma_f32_16x16x32_bf16 v[12:15], v[192:195], v[16:19], 0
    v_mfma_f32_16x16x32_bf16 v[12:15], v[196:199], v[20:23], v[12:15]
    v_mfma_f32_16x16x32_bf16 v[12:15], v[200:203], v[24:27], v[12:15]
    v_mfma_f32_16x16x32_bf16 v[12:15], v[204:207], v[28:31], v[12:15]
    buffer_load_dwordx4 v[128:131], v2, s[24:27], s30 offen offset:0 nt
    buffer_load_dwordx4 v[132:135], v2, s[24:27], s30 offen offset:1024 nt
    buffer_load_dwordx4 v[136:139], v2, s[24:27], s30 offen offset:2048 nt
    buffer_load_dwordx4 v[140:143], v2, s[24:27], s30 offen offset:3072 nt
    s_add_u32 s30, s30, 16384
    s_nop 2
    v_cndmask_b32_e64 v6, v12, v13, s[32:33]
    v_cndmask_b32_e64 v6, v6, v14, s[34:35]
    v_cndmask_b32_e64 v6, v6, v15, s[36:37]
    s_nop 1
    v_add_f32_dpp v6, v6, v6 quad_perm:[1,0,3,2] row_mask:0xf bank_mask:0xf
    s_nop 1
    v_add_f32_dpp v6, v6, v6 quad_perm:[2,3,0,1] row_mask:0xf bank_mask:0xf
    v_cvt_pk_bf16_f32 v7, v6, v6
    v_lshlrev_b32 v7, 16, v7
    v_mul_f32 v7, 0x3db504f3, v7
    v_cvt_pk_bf16_f32 v7, v7, v7
    v_and_b32 v52, 0xffff0000, v7
    v_max_f32 v5, v5, v52
    ds_write_b32 v3, v52 offset:512
    s_waitcnt vmcnt(28)
    v_mfma_f32_16x16x32_bf16 v[12:15], v[208:211], v[16:19], 0
    v_mfma_f32_16x16x32_bf16 v[12:15], v[212:215], v[20:23], v[12:15]
    v_mfma_f32_16x16x32_bf16 v[12:15], v[216:219], v[24:27], v[12:15]
    v_mfma_f32_16x16x32_bf16 v[12:15], v[220:223], v[28:31], v[12:15]
    buffer_load_dwordx4 v[144:147], v2, s[24:27], s30 offen offset:0 nt
    buffer_load_dwordx4 v[148:151], v2, s[24:27], s30 offen offset:1024 nt
    buffer_load_dwordx4 v[152:155], v2, s[24:27], s30 offen offset:2048 nt
    buffer_load_dwordx4 v[156:159], v2, s[24:27], s30 offen offset:3072 nt
    s_add_u32 s30, s30, 16384
    s_nop 2
    v_cndmask_b32_e64 v6, v12, v13, s[32:33]
    v_cndmask_b32_e64 v6, v6, v14, s[34:35]
    v_cndmask_b32_e64 v6, v6, v15, s[36:37]
    s_nop 1
    v_add_f32_dpp v6, v6, v6 quad_perm:[1,0,3,2] row_mask:0xf bank_mask:0xf
    s_nop 1
    v_add_f32_dpp v6, v6, v6 quad_perm:[2,3,0,1] row_mask:0xf bank_mask:0xf
    v_cvt_pk_bf16_f32 v7, v6, v6
    v_lshlrev_b32 v7, 16, v7
    v_mul_f32 v7, 0x3db504f3, v7
    v_cvt_pk_bf16_f32 v7, v7, v7
    v_and_b32 v52, 0xffff0000, v7
    v_max_f32 v5, v5, v52
    ds_write_b32 v3, v52 offset:576
    s_waitcnt vmcnt(28)
    v_mfma_f32_16x16x32_bf16 v[12:15], v[224:227], v[16:19], 0
    v_mfma_f32_16x16x32_bf16 v[12:15], v[228:231], v[20:23], v[12:15]
    v_mfma_f32_16x16x32_bf16 v[12:15], v[232:235], v[24:27], v[12:15]
    v_mfma_f32_16x16x32_bf16 v[12:15], v[236:239], v[28:31], v[12:15]
    s_nop 7
    v_cndmask_b32_e64 v6, v12, v13, s[32:33]
    v_cndmask_b32_e64 v6, v6, v14, s[34:35]
    v_cndmask_b32_e64 v6, v6, v15, s[36:37]
    s_nop 1
    v_add_f32_dpp v6, v6, v6 quad_perm:[1,0,3,2] row_mask:0xf bank_mask:0xf
    s_nop 1
    v_add_f32_dpp v6, v6, v6 quad_perm:[2,3,0,1] row_mask:0xf bank_mask:0xf
    v_cvt_pk_bf16_f32 v7, v6, v6
    v_lshlrev_b32 v7, 16, v7
    v_mul_f32 v7, 0x3db504f3, v7
    v_cvt_pk_bf16_f32 v7, v7, v7
    v_and_b32 v52, 0xffff0000, v7
    v_max_f32 v5, v5, v52
    ds_write_b32 v3, v52 offset:640
    s_waitcnt vmcnt(24)
    v_mfma_f32_16x16x32_bf16 v[12:15], v[240:243], v[16:19], 0
    v_mfma_f32_16x16x32_bf16 v[12:15], v[244:247], v[20:23], v[12:15]
    v_mfma_f32_16x16x32_bf16 v[12:15], v[248:251], v[24:27], v[12:15]
    v_mfma_f32_16x16x32_bf16 v[12:15], v[252:255], v[28:31], v[12:15]
    s_nop 7
    v_cndmask_b32_e64 v6, v12, v13, s[32:33]
    v_cndmask_b32_e64 v6, v6, v14, s[34:35]
    v_cndmask_b32_e64 v6, v6, v15, s[36:37]
    s_nop 1
    v_add_f32_dpp v6, v6, v6 quad_perm:[1,0,3,2] row_mask:0xf bank_mask:0xf
    s_nop 1
    v_add_f32_dpp v6, v6, v6 quad_perm:[2,3,0,1] row_mask:0xf bank_mask:0xf
    v_cvt_pk_bf16_f32 v7, v6, v6
    v_lshlrev_b32 v7, 16, v7
    v_mul_f32 v7, 0x3db504f3, v7
    v_cvt_pk_bf16_f32 v7, v7, v7
    v_and_b32 v52, 0xffff0000, v7
    v_max_f32 v5, v5, v52
    ds_write_b32 v3, v52 offset:704
    s_waitcnt vmcnt(20)
    v_mfma_f32_16x16x32_bf16 v[12:15], v[64:67], v[16:19], 0
    v_mfma_f32_16x16x32_bf16 v[12:15], v[68:71], v[20:23], v[12:15]
    v_mfma_f32_16x16x32_bf16 v[12:15], v[72:75], v[24:27], v[12:15]
    v_mfma_f32_16x16x32_bf16 v[12:15], v[76:79], v[28:31], v[12:15]
    s_nop 7
    v_cndmask_b32_e64 v6, v12, v13, s[32:33]
    v_cndmask_b32_e64 v6, v6, v14, s[34:35]
    v_cndmask_b32_e64 v6, v6, v15, s[36:37]
    s_nop 1
    v_add_f32_dpp v6, v6, v6 quad_perm:[1,0,3,2] row_mask:0xf bank_mask:0xf
    s_nop 1
    v_add_f32_dpp v6, v6, v6 quad_perm:[2,3,0,1] row_mask:0xf bank_mask:0xf
    v_cvt_pk_bf16_f32 v7, v6, v6
    v_lshlrev_b32 v7, 16, v7
    v_mul_f32 v7, 0x3db504f3, v7
    v_cvt_pk_bf16_f32 v7, v7, v7
    v_and_b32 v52, 0xffff0000, v7
    s_nop 1
    v_mov_b32_dpp v8, v52 row_shl:4 row_mask:0xf bank_mask:0xf
    v_mov_b32_dpp v9, v52 row_shl:8 row_mask:0xf bank_mask:0xf
    v_mov_b32_dpp v10, v52 row_shl:12 row_mask:0xf bank_mask:0xf
    v_cvt_pk_bf16_f32 v56, v52, v8
    v_cvt_pk_bf16_f32 v58, v9, v10
    s_waitcnt vmcnt(16)
    v_mfma_f32_16x16x32_bf16 v[12:15], v[80:83], v[16:19], 0
    v_mfma_f32_16x16x32_bf16 v[12:15], v[84:87], v[20:23], v[12:15]
    v_mfma_f32_16x16x32_bf16 v[12:15], v[88:91], v[24:27], v[12:15]
    v_mfma_f32_16x16x32_bf16 v[12:15], v[92:95], v[28:31], v[12:15]
    s_nop 7
    v_cndmask_b32_e64 v6, v12, v13, s[32:33]
    v_cndmask_b32_e64 v6, v6, v14, s[34:35]
    v_cndmask_b32_e64 v6, v6, v15, s[36:37]
    s_nop 1
    v_add_f32_dpp v6, v6, v6 quad_perm:[1,0,3,2] row_mask:0xf bank_mask:0xf
    s_nop 1
    v_add_f32_dpp v6, v6, v6 quad_perm:[2,3,0,1] row_mask:0xf bank_mask:0xf
    v_cvt_pk_bf16_f32 v7, v6, v6
    v_lshlrev_b32 v7, 16, v7
    v_mul_f32 v7, 0x3db504f3, v7
    v_cvt_pk_bf16_f32 v7, v7, v7
    v_and_b32 v52, 0xffff0000, v7
    s_nop 1
    v_mov_b32_dpp v8, v52 row_shl:4 row_mask:0xf bank_mask:0xf
    v_mov_b32_dpp v9, v52 row_shl:8 row_mask:0xf bank_mask:0xf
    v_mov_b32_dpp v10, v52 row_shl:12 row_mask:0xf bank_mask:0xf
    v_cvt_pk_bf16_f32 v8, v52, v8
    v_cvt_pk_bf16_f32 v9, v9, v10
    s_nop 0
    v_mov_b32_dpp v56, v8 row_shr:1 row_mask:0xf bank_mask:0xf
    v_mov_b32_dpp v58, v9 row_shr:1 row_mask:0xf bank_mask:0xf
    s_waitcnt vmcnt(12)
    v_mfma_f32_16x16x32_bf16 v[12:15], v[96:99], v[16:19], 0
    v_mfma_f32_16x16x32_bf16 v[12:15], v[100:103], v[20:23], v[12:15]
    v_mfma_f32_16x16x32_bf16 v[12:15], v[104:107], v[24:27], v[12:15]
    v_mfma_f32_16x16x32_bf16 v[12:15], v[108:111], v[28:31], v[12:15]
    s_nop 7
    v_cndmask_b32_e64 v6, v12, v13, s[32:33]
    v_cndmask_b32_e64 v6, v6, v14, s[34:35]
    v_cndmask_b32_e64 v6, v6, v15, s[36:37]
    s_nop 1
    v_add_f32_dpp v6, v6, v6 quad_perm:[1,0,3,2] row_mask:0xf bank_mask:0xf
    s_nop 1
    v_add_f32_dpp v6, v6, v6 quad_perm:[2,3,0,1] row_mask:0xf bank_mask:0xf
    v_cvt_pk_bf16_f32 v7, v6, v6
    v_lshlrev_b32 v7, 16, v7
    v_mul_f32 v7, 0x3db504f3, v7
    v_cvt_pk_bf16_f32 v7, v7, v7
    v_and_b32 v52, 0xffff0000, v7
    s_nop 1
    v_mov_b32_dpp v8, v52 row_shl:4 row_mask:0xf bank_mask:0xf
    v_mov_b32_dpp v9, v52 row_shl:8 row_mask:0xf bank_mask:0xf
    v_mov_b32_dpp v10, v52 row_shl:12 row_mask:0xf bank_mask:0xf
    v_cvt_pk_bf16_f32 v8, v52, v8
    v_cvt_pk_bf16_f32 v9, v9, v10
    s_nop 0
    v_mov_b32_dpp v56, v8 row_shr:2 row_mask:0xf bank_mask:0xf
    v_mov_b32_dpp v58, v9 row_shr:2 row_mask:0xf bank_mask:0xf
    s_waitcnt vmcnt(8)
    v_mfma_f32_16x16x32_bf16 v[12:15], v[112:115], v[16:19], 0
    v_mfma_f32_16x16x32_bf16 v[12:15], v[116:119], v[20:23], v[12:15]
    v_mfma_f32_16x16x32_bf16 v[12:15], v[120:123], v[24:27], v[12:15]
    v_mfma_f32_16x16x32_bf16 v[12:15], v[124:127], v[28:31], v[12:15]
    s_nop 7
    v_cndmask_b32_e64 v6, v12, v13, s[32:33]
    v_cndmask_b32_e64 v6, v6, v14, s[34:35]
    v_cndmask_b32_e64 v6, v6, v15, s[36:37]
    s_nop 1
    v_add_f32_dpp v6, v6, v6 quad_perm:[1,0,3,2] row_mask:0xf bank_mask:0xf
    s_nop 1
    v_add_f32_dpp v6, v6, v6 quad_perm:[2,3,0,1] row_mask:0xf bank_mask:0xf
    v_cvt_pk_bf16_f32 v7, v6, v6
    v_lshlrev_b32 v7, 16, v7
    v_mul_f32 v7, 0x3db504f3, v7
    v_cvt_pk_bf16_f32 v7, v7, v7
    v_and_b32 v52, 0xffff0000, v7
    s_nop 1
    v_mov_b32_dpp v8, v52 row_shl:4 row_mask:0xf bank_mask:0xf
    v_mov_b32_dpp v9, v52 row_shl:8 row_mask:0xf bank_mask:0xf
    v_mov_b32_dpp v10, v52 row_shl:12 row_mask:0xf bank_mask:0xf
    v_cvt_pk_bf16_f32 v8, v52, v8
    v_cvt_pk_bf16_f32 v9, v9, v10
    s_nop 0
    v_mov_b32_dpp v56, v8 row_shr:3 row_mask:0xf bank_mask:0xf
    v_mov_b32_dpp v58, v9 row_shr:3 row_mask:0xf bank_mask:0xf
    s_mov_b64 exec, s[56:57]
    buffer_store_dwordx4 v[56:59], v4, s[8:11], s39 offen sc1
    s_mov_b64 exec, -1
    v_max_f32_dpp v5, v5, v5 row_shr:1 row_mask:0xf bank_mask:0xf
    s_nop 1
    v_max_f32_dpp v5, v5, v5 row_shr:2 row_mask:0xf bank_mask:0xf
    s_nop 1
    v_max_f32_dpp v5, v5, v5 row_shr:4 row_mask:0xf bank_mask:0xf
    s_nop 1
    v_max_f32_dpp v5, v5, v5 row_shr:8 row_mask:0xf bank_mask:0xf
    s_nop 1
    v_max_f32_dpp v5, v5, v5 row_bcast:15 row_mask:0xa bank_mask:0xf
    s_nop 1
    v_max_f32_dpp v5, v5, v5 row_bcast:31 row_mask:0xc bank_mask:0xf
    s_nop 0
    v_readlane_b32 s38, v5, 63
    v_subrev_u32 v3, 3072, v3
    v_and_b32 v6, 7, v0
    v_and_b32 v7, 1, v6
    v_lshrrev_b32 v6, 1, v6
    v_cmp_eq_u32 vcc, 1, v7
    v_mov_b32 v8, 0xffff
    v_mov_b32 v9, 0xffff0000
    v_cndmask_b32 v8, v8, v9, vcc
    v_cmp_eq_u32 vcc, 0, v6
    s_nop 1
    v_cndmask_b32 v16, 0, v8, vcc
    v_cmp_eq_u32 vcc, 1, v6
    s_nop 1
    v_cndmask_b32 v17, 0, v8, vcc
    v_cmp_eq_u32 vcc, 2, v6
    s_nop 1
    v_cndmask_b32 v18, 0, v8, vcc
    v_cmp_eq_u32 vcc, 3, v6
    s_nop 1
    v_cndmask_b32 v19, 0, v8, vcc
    v_mov_b32 v12, 0
    v_mov_b32 v13, 0
    v_mov_b32 v14, 0
    v_mov_b32 v15, 0
    v_mov_b32 v5, 0
    v_mov_b32 v61, 0
    ds_read_b32 v10, v3
    s_lshl_b32 s40, s5, 8
    s_add_u32 s40, s40, 65536
    v_mov_b32 v50, s40
    s_mov_b32 s44, s8
    s_mov_b32 s45, s9
    s_mov_b32 s46, 6291456
    s_mov_b32 s47, 0x20000
    s_mov_b32 s48, s8
    s_mov_b32 s49, s9
    s_mov_b32 s50, 6291456
    s_mov_b32 s51, 0x20000
    s_mul_i32 s41, s5, 8192
    s_add_u32 s41, s41, 2097152
    s_mov_b32 s52, 0
    s_mov_b32 s53, -1
    s_lshl_b32 s75, s4, 2
    s_add_u32 s75, s75, s29
    s_mov_b32 s73, 496
    s_mov_b32 s74, 240
    s_mov_b32 s55, 0
    s_mov_b32 s43, 2
L_VLOOP_E:
    s_waitcnt lgkmcnt(0)
    v_subrev_f32 v6, s38, v10
    v_mul_f32 v6, 0x3fb8aa3b, v6
    v_exp_f32 v6, v6
    ds_read_b32 v11, v3 offset:64
    v_add_f32 v5, v5, v6
    v_cvt_pk_bf16_f32 v7, v6, v6
    s_nop 1
    v_and_b32_dpp v20, v7, v16 row_newbcast:0 row_mask:0xf bank_mask:0xf
    v_and_b32_dpp v21, v7, v17 row_newbcast:0 row_mask:0xf bank_mask:0xf
    v_and_b32_dpp v22, v7, v18 row_newbcast:0 row_mask:0xf bank_mask:0xf
    v_and_b32_dpp v23, v7, v19 row_newbcast:0 row_mask:0xf bank_mask:0xf
    v_and_b32_dpp v24, v7, v16 row_newbcast:4 row_mask:0xf bank_mask:0xf
    v_and_b32_dpp v25, v7, v17 row_newbcast:4 row_mask:0xf bank_mask:0xf
    v_and_b32_dpp v26, v7, v18 row_newbcast:4 row_mask:0xf bank_mask:0xf
    v_and_b32_dpp v27, v7, v19 row_newbcast:4 row_mask:0xf bank_mask:0xf
    s_waitcnt vmcnt(4)
    v_mfma_f32_16x16x32_bf16 v[12:15], v[128:131], v[20:23], v[12:15]
    v_and_b32_dpp v20, v7, v16 row_newbcast:8 row_mask:0xf bank_mask:0xf
    v_and_b32_dpp v21, v7, v17 row_newbcast:8 row_mask:0xf bank_mask:0xf
    v_and_b32_dpp v22, v7, v18 row_newbcast:8 row_mask:0xf bank_mask:0xf
    v_and_b32_dpp v23, v7, v19 row_newbcast:8 row_mask:0xf bank_mask:0xf
    v_mfma_f32_16x16x32_bf16 v[12:15], v[132:135], v[24:27], v[12:15]
    v_and_b32_dpp v24, v7, v16 row_newbcast:12 row_mask:0xf bank_mask:0xf
    v_and_b32_dpp v25, v7, v17 row_newbcast:12 row_mask:0xf bank_mask:0xf
    v_and_b32_dpp v26, v7, v18 row_newbcast:12 row_mask:0xf bank_mask:0xf
    v_and_b32_dpp v27, v7, v19 row_newbcast:12 row_mask:0xf bank_mask:0xf
    v_mfma_f32_16x16x32_bf16 v[12:15], v[136:139], v[20:23], v[12:15]
    s_nop 0
    v_mfma_f32_16x16x32_bf16 v[12:15], v[140:143], v[24:27], v[12:15]
    buffer_load_dwordx4 v[128:131], v2, s[24:27], s30 offen offset:0 nt
    buffer_load_dwordx4 v[132:135], v2, s[24:27], s30 offen offset:1024 nt
    buffer_load_dwordx4 v[136:139], v2, s[24:27], s30 offen offset:2048 nt
    buffer_load_dwordx4 v[140:143], v2, s[24:27], s30 offen offset:3072 nt
    s_add_u32 s30, s30, 16384
    s_waitcnt lgkmcnt(0)
    v_subrev_f32 v6, s38, v11
    v_mul_f32 v6, 0x3fb8aa3b, v6
    v_exp_f32 v6, v6
    ds_read_b32 v10, v3 offset:128
    v_add_f32 v5, v5, v6
    v_cvt_pk_bf16_f32 v7, v6, v6
    s_nop 1
    v_and_b32_dpp v20, v7, v16 row_newbcast:0 row_mask:0xf bank_mask:0xf
    v_and_b32_dpp v21, v7, v17 row_newbcast:0 row_mask:0xf bank_mask:0xf
    v_and_b32_dpp v22, v7, v18 row_newbcast:0 row_mask:0xf bank_mask:0xf
    v_and_b32_dpp v23, v7, v19 row_newbcast:0 row_mask:0xf bank_mask:0xf
    v_and_b32_dpp v24, v7, v16 row_newbcast:4 row_mask:0xf bank_mask:0xf
    v_and_b32_dpp v25, v7, v17 row_newbcast:4 row_mask:0xf bank_mask:0xf
    v_and_b32_dpp v26, v7, v18 row_newbcast:4 row_mask:0xf bank_mask:0xf
    v_and_b32_dpp v27, v7, v19 row_newbcast:4 row_mask:0xf bank_mask:0xf
    s_waitcnt vmcnt(4)
    v_mfma_f32_16x16x32_bf16 v[12:15], v[144:147], v[20:23], v[12:15]
    v_and_b32_dpp v20, v7, v16 row_newbcast:8 row_mask:0xf bank_mask:0xf
    v_and_b32_dpp v21, v7, v17 row_newbcast:8 row_mask:0xf bank_mask:0xf
    v_and_b32_dpp v22, v7, v18 row_newbcast:8 row_mask:0xf bank_mask:0xf
    v_and_b32_dpp v23, v7, v19 row_newbcast:8 row_mask:0xf bank_mask:0xf
    v_mfma_f32_16x16x32_bf16 v[12:15], v[148:151], v[24:27], v[12:15]
    v_and_b32_dpp v24, v7, v16 row_newbcast:12 row_mask:0xf bank_mask:0xf
    v_and_b32_dpp v25, v7, v17 row_newbcast:12 row_mask:0xf bank_mask:0xf
    v_and_b32_dpp v26, v7, v18 row_newbcast:12 row_mask:0xf bank_mask:0xf
    v_and_b32_dpp v27, v7, v19 row_newbcast:12 row_mask:0xf bank_mask:0xf
    v_mfma_f32_16x16x32_bf16 v[12:15], v[152:155], v[20:23], v[12:15]
    s_nop 0
    v_mfma_f32_16x16x32_bf16 v[12:15], v[156:159], v[24:27], v[12:15]
    buffer_load_dwordx4 v[144:147], v2, s[24:27], s30 offen offset:0 nt
    buffer_load_dwordx4 v[148:151], v2, s[24:27], s30 offen offset:1024 nt
    buffer_load_dwordx4 v[152:155], v2, s[24:27], s30 offen offset:2048 nt
    buffer_load_dwordx4 v[156:159], v2, s[24:27], s30 offen offset:3072 nt
    s_add_u32 s30, s30, 16384
    v_add_u32 v3, 128, v3
    s_add_u32 s55, s55, 1
    s_cmp_lt_u32 s55, 28
    s_cbranch_scc1 L_VLOOP_E
    s_waitcnt lgkmcnt(0)
    v_subrev_f32 v6, s38, v10
    v_mul_f32 v6, 0x3fb8aa3b, v6
    v_exp_f32 v6, v6
    ds_read_b32 v11, v3 offset:64
    v_add_f32 v5, v5, v6
    v_cvt_pk_bf16_f32 v7, v6, v6
    s_nop 1
    v_and_b32_dpp v20, v7, v16 row_newbcast:0 row_mask:0xf bank_mask:0xf
    v_and_b32_dpp v21, v7, v17 row_newbcast:0 row_mask:0xf bank_mask:0xf
    v_and_b32_dpp v22, v7, v18 row_newbcast:0 row_mask:0xf bank_mask:0xf
    v_and_b32_dpp v23, v7, v19 row_newbcast:0 row_mask:0xf bank_mask:0xf
    v_and_b32_dpp v24, v7, v16 row_newbcast:4 row_mask:0xf bank_mask:0xf
    v_and_b32_dpp v25, v7, v17 row_newbcast:4 row_mask:0xf bank_mask:0xf
    v_and_b32_dpp v26, v7, v18 row_newbcast:4 row_mask:0xf bank_mask:0xf
    v_and_b32_dpp v27, v7, v19 row_newbcast:4 row_mask:0xf bank_mask:0xf
    s_waitcnt vmcnt(4)
    v_mfma_f32_16x16x32_bf16 v[12:15], v[128:131], v[20:23], v[12:15]
    v_and_b32_dpp v20, v7, v16 row_newbcast:8 row_mask:0xf bank_mask:0xf
    v_and_b32_dpp v21, v7, v17 row_newbcast:8 row_mask:0xf bank_mask:0xf
    v_and_b32_dpp v22, v7, v18 row_newbcast:8 row_mask:0xf bank_mask:0xf
    v_and_b32_dpp v23, v7, v19 row_newbcast:8 row_mask:0xf bank_mask:0xf
    v_mfma_f32_16x16x32_bf16 v[12:15], v[132:135], v[24:27], v[12:15]
    v_and_b32_dpp v24, v7, v16 row_newbcast:12 row_mask:0xf bank_mask:0xf
    v_and_b32_dpp v25, v7, v17 row_newbcast:12 row_mask:0xf bank_mask:0xf
    v_and_b32_dpp v26, v7, v18 row_newbcast:12 row_mask:0xf bank_mask:0xf
    v_and_b32_dpp v27, v7, v19 row_newbcast:12 row_mask:0xf bank_mask:0xf
    v_mfma_f32_16x16x32_bf16 v[12:15], v[136:139], v[20:23], v[12:15]
    s_nop 0
    v_mfma_f32_16x16x32_bf16 v[12:15], v[140:143], v[24:27], v[12:15]
    s_mov_b64 exec, 1
    v_mov_b32 v44, 1
    buffer_atomic_add v44, v50, s[48:51], 0 offen sc0
    s_mov_b64 exec, -1
    buffer_load_dwordx4 v[128:131], v2, s[24:27], s30 offen offset:0 nt
    buffer_load_dwordx4 v[132:135], v2, s[24:27], s30 offen offset:1024 nt
    buffer_load_dwordx4 v[136:139], v2, s[24:27], s30 offen offset:2048 nt
    buffer_load_dwordx4 v[140:143], v2, s[24:27], s30 offen offset:3072 nt
    s_add_u32 s30, s30, 16384
    s_waitcnt lgkmcnt(0)
    v_subrev_f32 v6, s38, v11
    v_mul_f32 v6, 0x3fb8aa3b, v6
    v_exp_f32 v6, v6
    ds_read_b32 v10, v3 offset:128
    v_add_f32 v5, v5, v6
    v_cvt_pk_bf16_f32 v7, v6, v6
    s_nop 1
    v_and_b32_dpp v20, v7, v16 row_newbcast:0 row_mask:0xf bank_mask:0xf
    v_and_b32_dpp v21, v7, v17 row_newbcast:0 row_mask:0xf bank_mask:0xf
    v_and_b32_dpp v22, v7, v18 row_newbcast:0 row_mask:0xf bank_mask:0xf
    v_and_b32_dpp v23, v7, v19 row_newbcast:0 row_mask:0xf bank_mask:0xf
    v_and_b32_dpp v24, v7, v16 row_newbcast:4 row_mask:0xf bank_mask:0xf
    v_and_b32_dpp v25, v7, v17 row_newbcast:4 row_mask:0xf bank_mask:0xf
    v_and_b32_dpp v26, v7, v18 row_newbcast:4 row_mask:0xf bank_mask:0xf
    v_and_b32_dpp v27, v7, v19 row_newbcast:4 row_mask:0xf bank_mask:0xf
    s_waitcnt vmcnt(5)
    v_mfma_f32_16x16x32_bf16 v[12:15], v[144:147], v[20:23], v[12:15]
    v_and_b32_dpp v20, v7, v16 row_newbcast:8 row_mask:0xf bank_mask:0xf
    v_and_b32_dpp v21, v7, v17 row_newbcast:8 row_mask:0xf bank_mask:0xf
    v_and_b32_dpp v22, v7, v18 row_newbcast:8 row_mask:0xf bank_mask:0xf
    v_and_b32_dpp v23, v7, v19 row_newbcast:8 row_mask:0xf bank_mask:0xf
    v_mfma_f32_16x16x32_bf16 v[12:15], v[148:151], v[24:27], v[12:15]
    v_and_b32_dpp v24, v7, v16 row_newbcast:12 row_mask:0xf bank_mask:0xf
    v_and_b32_dpp v25, v7, v17 row_newbcast:12 row_mask:0xf bank_mask:0xf
    v_and_b32_dpp v26, v7, v18 row_newbcast:12 row_mask:0xf bank_mask:0xf
    v_and_b32_dpp v27, v7, v19 row_newbcast:12 row_mask:0xf bank_mask:0xf
    v_mfma_f32_16x16x32_bf16 v[12:15], v[152:155], v[20:23], v[12:15]
    s_nop 0
    v_mfma_f32_16x16x32_bf16 v[12:15], v[156:159], v[24:27], v[12:15]
    s_mov_b64 exec, 1
    v_mov_b32 v45, 1
    buffer_atomic_add v45, v50, s[48:51], 0 offen sc0
    s_mov_b64 exec, -1
    buffer_load_dwordx4 v[144:147], v2, s[24:27], s30 offen offset:0 nt
    buffer_load_dwordx4 v[148:151], v2, s[24:27], s30 offen offset:1024 nt
    buffer_load_dwordx4 v[152:155], v2, s[24:27], s30 offen offset:2048 nt
    buffer_load_dwordx4 v[156:159], v2, s[24:27], s30 offen offset:3072 nt
    s_add_u32 s30, s30, 16384
    s_waitcnt lgkmcnt(0)
    v_subrev_f32 v6, s38, v10
    v_mul_f32 v6, 0x3fb8aa3b, v6
    v_exp_f32 v6, v6
    ds_read_b32 v11, v3 offset:192
    v_add_f32 v5, v5, v6
    v_cvt_pk_bf16_f32 v7, v6, v6
    s_nop 1
    v_and_b32_dpp v20, v7, v16 row_newbcast:0 row_mask:0xf bank_mask:0xf
    v_and_b32_dpp v21, v7, v17 row_newbcast:0 row_mask:0xf bank_mask:0xf
    v_and_b32_dpp v22, v7, v18 row_newbcast:0 row_mask:0xf bank_mask:0xf
    v_and_b32_dpp v23, v7, v19 row_newbcast:0 row_mask:0xf bank_mask:0xf
    v_and_b32_dpp v24, v7, v16 row_newbcast:4 row_mask:0xf bank_mask:0xf
    v_and_b32_dpp v25, v7, v17 row_newbcast:4 row_mask:0xf bank_mask:0xf
    v_and_b32_dpp v26, v7, v18 row_newbcast:4 row_mask:0xf bank_mask:0xf
    v_and_b32_dpp v27, v7, v19 row_newbcast:4 row_mask:0xf bank_mask:0xf
    s_waitcnt vmcnt(5)
    v_mfma_f32_16x16x32_bf16 v[12:15], v[128:131], v[20:23], v[12:15]
    v_and_b32_dpp v20, v7, v16 row_newbcast:8 row_mask:0xf bank_mask:0xf
    v_and_b32_dpp v21, v7, v17 row_newbcast:8 row_mask:0xf bank_mask:0xf
    v_and_b32_dpp v22, v7, v18 row_newbcast:8 row_mask:0xf bank_mask:0xf
    v_and_b32_dpp v23, v7, v19 row_newbcast:8 row_mask:0xf bank_mask:0xf
    v_mfma_f32_16x16x32_bf16 v[12:15], v[132:135], v[24:27], v[12:15]
    v_and_b32_dpp v24, v7, v16 row_newbcast:12 row_mask:0xf bank_mask:0xf
    v_and_b32_dpp v25, v7, v17 row_newbcast:12 row_mask:0xf bank_mask:0xf
    v_and_b32_dpp v26, v7, v18 row_newbcast:12 row_mask:0xf bank_mask:0xf
    v_and_b32_dpp v27, v7, v19 row_newbcast:12 row_mask:0xf bank_mask:0xf
    v_mfma_f32_16x16x32_bf16 v[12:15], v[136:139], v[20:23], v[12:15]
    s_nop 0
    v_mfma_f32_16x16x32_bf16 v[12:15], v[140:143], v[24:27], v[12:15]
    s_mov_b32 s58, 0
    v_readfirstlane_b32 s54, v44
    s_cmp_lt_u32 s54, 128
    s_cselect_b32 s26, s26, 0
    s_cselect_b32 s46, s46, 0
    s_cselect_b32 s50, s50, 0
    s_cselect_b32 s58, -1, s58
    s_min_u32 s53, s53, s58
    s_mul_hi_u32 s67, s54, 134217728
    s_mul_i32 s68, s67, 32
    s_sub_u32 s69, s54, s68
    s_cmp_ge_u32 s69, 16
    s_cselect_b32 s70, 16, 0
    s_cselect_b32 s71, 4, 4
    s_cselect_b32 s72, s73, s74
    s_sub_u32 s69, s69, s70
    s_add_u32 s68, s68, s70
    s_and_b32 s43, s69, 3
    s_mul_i32 s43, s43, s71
    s_lshr_b32 s59, s69, 2
    s_add_u32 s43, s43, s59
    s_add_u32 s68, s68, s43
    s_lshl_b32 s68, s68, 6
    s_add_u32 s60, s68, s41
    s_lshl_b32 s59, s67, 9
    s_add_u32 s59, s59, s72
    s_add_u32 s59, s59, s69
    s_lshl_b32 s59, s59, 12
    s_mov_b64 exec, 1
    v_mov_b32 v44, 1
    buffer_atomic_add v44, v50, s[48:51], 0 offen sc0
    s_mov_b64 exec, -1
    buffer_load_dwordx2 v[32:33], v51, s[44:47], s60 offen sc1
    buffer_load_dwordx4 v[128:131], v2, s[24:27], s59 offen offset:0 nt
    buffer_load_dwordx4 v[132:135], v2, s[24:27], s59 offen offset:1024 nt
    buffer_load_dwordx4 v[136:139], v2, s[24:27], s59 offen offset:2048 nt
    buffer_load_dwordx4 v[140:143], v2, s[24:27], s59 offen offset:3072 nt
    s_waitcnt lgkmcnt(0)
    v_subrev_f32 v6, s38, v11
    v_mul_f32 v6, 0x3fb8aa3b, v6
    v_exp_f32 v6, v6
    s_nop 0
    v_add_f32 v5, v5, v6
    v_cvt_pk_bf16_f32 v7, v6, v6
    s_nop 1
    v_and_b32_dpp v20, v7, v16 row_newbcast:0 row_mask:0xf bank_mask:0xf
    v_and_b32_dpp v21, v7, v17 row_newbcast:0 row_mask:0xf bank_mask:0xf
    v_and_b32_dpp v22, v7, v18 row_newbcast:0 row_mask:0xf bank_mask:0xf
    v_and_b32_dpp v23, v7, v19 row_newbcast:0 row_mask:0xf bank_mask:0xf
    v_and_b32_dpp v24, v7, v16 row_newbcast:4 row_mask:0xf bank_mask:0xf
    v_and_b32_dpp v25, v7, v17 row_newbcast:4 row_mask:0xf bank_mask:0xf
    v_and_b32_dpp v26, v7, v18 row_newbcast:4 row_mask:0xf bank_mask:0xf
    v_and_b32_dpp v27, v7, v19 row_newbcast:4 row_mask:0xf bank_mask:0xf
    s_waitcnt vmcnt(6)
    v_mfma_f32_16x16x32_bf16 v[12:15], v[144:147], v[20:23], v[12:15]
    v_and_b32_dpp v20, v7, v16 row_newbcast:8 row_mask:0xf bank_mask:0xf
    v_and_b32_dpp v21, v7, v17 row_newbcast:8 row_mask:0xf bank_mask:0xf
    v_and_b32_dpp v22, v7, v18 row_newbcast:8 row_mask:0xf bank_mask:0xf
    v_and_b32_dpp v23, v7, v19 row_newbcast:8 row_mask:0xf bank_mask:0xf
    v_mfma_f32_16x16x32_bf16 v[12:15], v[148:151], v[24:27], v[12:15]
    v_and_b32_dpp v24, v7, v16 row_newbcast:12 row_mask:0xf bank_mask:0xf
    v_and_b32_dpp v25, v7, v17 row_newbcast:12 row_mask:0xf bank_mask:0xf
    v_and_b32_dpp v26, v7, v18 row_newbcast:12 row_mask:0xf bank_mask:0xf
    v_and_b32_dpp v27, v7, v19 row_newbcast:12 row_mask:0xf bank_mask:0xf
    v_mfma_f32_16x16x32_bf16 v[12:15], v[152:155], v[20:23], v[12:15]
    s_nop 0
    v_mfma_f32_16x16x32_bf16 v[12:15], v[156:159], v[24:27], v[12:15]
    s_mov_b32 s58, 1
    v_readfirstlane_b32 s54, v45
    s_cmp_lt_u32 s54, 128
    s_cselect_b32 s26, s26, 0
    s_cselect_b32 s46, s46, 0
    s_cselect_b32 s50, s50, 0
    s_cselect_b32 s58, -1, s58
    s_min_u32 s53, s53, s58
    s_mul_hi_u32 s67, s54, 134217728
    s_mul_i32 s68, s67, 32
    s_sub_u32 s69, s54, s68
    s_cmp_ge_u32 s69, 16
    s_cselect_b32 s70, 16, 0
    s_cselect_b32 s71, 4, 4
    s_cselect_b32 s72, s73, s74
    s_sub_u32 s69, s69, s70
    s_add_u32 s68, s68, s70
    s_and_b32 s43, s69, 3
    s_mul_i32 s43, s43, s71
    s_lshr_b32 s59, s69, 2
    s_add_u32 s43, s43, s59
    s_add_u32 s68, s68, s43
    s_lshl_b32 s68, s68, 6
    s_add_u32 s61, s68, s41
    s_lshl_b32 s59, s67, 9
    s_add_u32 s59, s59, s72
    s_add_u32 s59, s59, s69
    s_lshl_b32 s59, s59, 12
    s_mov_b64 exec, 1
    v_mov_b32 v45, 1
    buffer_atomic_add v45, v50, s[48:51], 0 offen sc0
    s_mov_b64 exec, -1
    buffer_load_dwordx2 v[34:35], v51, s[44:47], s61 offen sc1
    buffer_load_dwordx4 v[144:147], v2, s[24:27], s59 offen offset:0 nt
    buffer_load_dwordx4 v[148:151], v2, s[24:27], s59 offen offset:1024 nt
    buffer_load_dwordx4 v[152:155], v2, s[24:27], s59 offen offset:2048 nt
    buffer_load_dwordx4 v[156:159], v2, s[24:27], s59 offen offset:3072 nt
L_PLOOP_E:
    s_waitcnt vmcnt(6)
    s_cmp_eq_u32 s52, s53
    s_cbranch_scc1 L_VDONE_E
    v_cmp_ne_u32 vcc, s12, v33
    s_cbranch_vccnz L_RETRY_0_E
L_RETB_0_E:
    v_lshlrev_b32 v32, v54, v32
    v_and_b32 v32, 0xffff0000, v32
    v_cmp_lt_f32 vcc, s38, v32
    s_cbranch_vccnz L_RESC_0_E
L_RESB_0_E:
    v_subrev_f32 v6, s38, v32
    v_mul_f32 v6, 0x3fb8aa3b, v6
    v_exp_f32 v6, v6
    s_nop 0
    v_add_f32 v5, v5, v6
    v_cvt_pk_bf16_f32 v7, v6, v6
    s_nop 1
    v_and_b32_dpp v20, v7, v16 row_newbcast:0 row_mask:0xf bank_mask:0xf
    v_and_b32_dpp v21, v7, v17 row_newbcast:0 row_mask:0xf bank_mask:0xf
    v_and_b32_dpp v22, v7, v18 row_newbcast:0 row_mask:0xf bank_mask:0xf
    v_and_b32_dpp v23, v7, v19 row_newbcast:0 row_mask:0xf bank_mask:0xf
    v_and_b32_dpp v24, v7, v16 row_newbcast:4 row_mask:0xf bank_mask:0xf
    v_and_b32_dpp v25, v7, v17 row_newbcast:4 row_mask:0xf bank_mask:0xf
    v_and_b32_dpp v26, v7, v18 row_newbcast:4 row_mask:0xf bank_mask:0xf
    v_and_b32_dpp v27, v7, v19 row_newbcast:4 row_mask:0xf bank_mask:0xf
    v_mfma_f32_16x16x32_bf16 v[12:15], v[128:131], v[20:23], v[12:15]
    v_and_b32_dpp v20, v7, v16 row_newbcast:8 row_mask:0xf bank_mask:0xf
    v_and_b32_dpp v21, v7, v17 row_newbcast:8 row_mask:0xf bank_mask:0xf
    v_and_b32_dpp v22, v7, v18 row_newbcast:8 row_mask:0xf bank_mask:0xf
    v_and_b32_dpp v23, v7, v19 row_newbcast:8 row_mask:0xf bank_mask:0xf
    v_mfma_f32_16x16x32_bf16 v[12:15], v[132:135], v[24:27], v[12:15]
    v_and_b32_dpp v24, v7, v16 row_newbcast:12 row_mask:0xf bank_mask:0xf
    v_and_b32_dpp v25, v7, v17 row_newbcast:12 row_mask:0xf bank_mask:0xf
    v_and_b32_dpp v26, v7, v18 row_newbcast:12 row_mask:0xf bank_mask:0xf
    v_and_b32_dpp v27, v7, v19 row_newbcast:12 row_mask:0xf bank_mask:0xf
    v_mfma_f32_16x16x32_bf16 v[12:15], v[136:139], v[20:23], v[12:15]
    s_nop 0
    v_mfma_f32_16x16x32_bf16 v[12:15], v[140:143], v[24:27], v[12:15]
    s_add_u32 s58, s52, 2
    v_readfirstlane_b32 s54, v44
    s_cmp_lt_u32 s54, 128
    s_cselect_b32 s26, s26, 0
    s_cselect_b32 s46, s46, 0
    s_cselect_b32 s50, s50, 0
    s_cselect_b32 s58, -1, s58
    s_min_u32 s53, s53, s58
    s_mul_hi_u32 s67, s54, 134217728
    s_mul_i32 s68, s67, 32
    s_sub_u32 s69, s54, s68
    s_cmp_ge_u32 s69, 16
    s_cselect_b32 s70, 16, 0
    s_cselect_b32 s71, 4, 4
    s_cselect_b32 s72, s73, s74
    s_sub_u32 s69, s69, s70
    s_add_u32 s68, s68, s70
    s_and_b32 s43, s69, 3
    s_mul_i32 s43, s43, s71
    s_lshr_b32 s59, s69, 2
    s_add_u32 s43, s43, s59
    s_add_u32 s68, s68, s43
    s_lshl_b32 s68, s68, 6
    s_add_u32 s60, s68, s41
    s_lshl_b32 s59, s67, 9
    s_add_u32 s59, s59, s72
    s_add_u32 s59, s59, s69
    s_lshl_b32 s59, s59, 12
    s_mov_b64 exec, 1
    v_mov_b32 v44, 1
    buffer_atomic_add v44, v50, s[48:51], 0 offen sc0
    s_mov_b64 exec, -1
    buffer_load_dwordx2 v[32:33], v51, s[44:47], s60 offen sc1
    buffer_load_dwordx4 v[128:131], v2, s[24:27], s59 offen offset:0 nt
    buffer_load_dwordx4 v[132:135], v2, s[24:27], s59 offen offset:1024 nt
    buffer_load_dwordx4 v[136:139], v2, s[24:27], s59 offen offset:2048 nt
    buffer_load_dwordx4 v[140:143], v2, s[24:27], s59 offen offset:3072 nt
    s_add_u32 s52, s52, 1
    s_waitcnt vmcnt(6)
    s_cmp_eq_u32 s52, s53
    s_cbranch_scc1 L_VDONE_E
    v_cmp_ne_u32 vcc, s12, v35
    s_cbranch_vccnz L_RETRY_1_E
L_RETB_1_E:
    v_lshlrev_b32 v34, v54, v34
    v_and_b32 v34, 0xffff0000, v34
    v_cmp_lt_f32 vcc, s38, v34
    s_cbranch_vccnz L_RESC_1_E
L_RESB_1_E:
    v_subrev_f32 v6, s38, v34
    v_mul_f32 v6, 0x3fb8aa3b, v6
    v_exp_f32 v6, v6
    s_nop 0
    v_add_f32 v5, v5, v6
    v_cvt_pk_bf16_f32 v7, v6, v6
    s_nop 1
    v_and_b32_dpp v20, v7, v16 row_newbcast:0 row_mask:0xf bank_mask:0xf
    v_and_b32_dpp v21, v7, v17 row_newbcast:0 row_mask:0xf bank_mask:0xf
    v_and_b32_dpp v22, v7, v18 row_newbcast:0 row_mask:0xf bank_mask:0xf
    v_and_b32_dpp v23, v7, v19 row_newbcast:0 row_mask:0xf bank_mask:0xf
    v_and_b32_dpp v24, v7, v16 row_newbcast:4 row_mask:0xf bank_mask:0xf
    v_and_b32_dpp v25, v7, v17 row_newbcast:4 row_mask:0xf bank_mask:0xf
    v_and_b32_dpp v26, v7, v18 row_newbcast:4 row_mask:0xf bank_mask:0xf
    v_and_b32_dpp v27, v7, v19 row_newbcast:4 row_mask:0xf bank_mask:0xf
    v_mfma_f32_16x16x32_bf16 v[12:15], v[144:147], v[20:23], v[12:15]
    v_and_b32_dpp v20, v7, v16 row_newbcast:8 row_mask:0xf bank_mask:0xf
    v_and_b32_dpp v21, v7, v17 row_newbcast:8 row_mask:0xf bank_mask:0xf
    v_and_b32_dpp v22, v7, v18 row_newbcast:8 row_mask:0xf bank_mask:0xf
    v_and_b32_dpp v23, v7, v19 row_newbcast:8 row_mask:0xf bank_mask:0xf
    v_mfma_f32_16x16x32_bf16 v[12:15], v[148:151], v[24:27], v[12:15]
    v_and_b32_dpp v24, v7, v16 row_newbcast:12 row_mask:0xf bank_mask:0xf
    v_and_b32_dpp v25, v7, v17 row_newbcast:12 row_mask:0xf bank_mask:0xf
    v_and_b32_dpp v26, v7, v18 row_newbcast:12 row_mask:0xf bank_mask:0xf
    v_and_b32_dpp v27, v7, v19 row_newbcast:12 row_mask:0xf bank_mask:0xf
    v_mfma_f32_16x16x32_bf16 v[12:15], v[152:155], v[20:23], v[12:15]
    s_nop 0
    v_mfma_f32_16x16x32_bf16 v[12:15], v[156:159], v[24:27], v[12:15]
    s_add_u32 s58, s52, 2
    v_readfirstlane_b32 s54, v45
    s_cmp_lt_u32 s54, 128
    s_cselect_b32 s26, s26, 0
    s_cselect_b32 s46, s46, 0
    s_cselect_b32 s50, s50, 0
    s_cselect_b32 s58, -1, s58
    s_min_u32 s53, s53, s58
    s_mul_hi_u32 s67, s54, 134217728
    s_mul_i32 s68, s67, 32
    s_sub_u32 s69, s54, s68
    s_cmp_ge_u32 s69, 16
    s_cselect_b32 s70, 16, 0
    s_cselect_b32 s71, 4, 4
    s_cselect_b32 s72, s73, s74
    s_sub_u32 s69, s69, s70
    s_add_u32 s68, s68, s70
    s_and_b32 s43, s69, 3
    s_mul_i32 s43, s43, s71
    s_lshr_b32 s59, s69, 2
    s_add_u32 s43, s43, s59
    s_add_u32 s68, s68, s43
    s_lshl_b32 s68, s68, 6
    s_add_u32 s61, s68, s41
    s_lshl_b32 s59, s67, 9
    s_add_u32 s59, s59, s72
    s_add_u32 s59, s59, s69
    s_lshl_b32 s59, s59, 12
    s_mov_b64 exec, 1
    v_mov_b32 v45, 1
    buffer_atomic_add v45, v50, s[48:51], 0 offen sc0
    s_mov_b64 exec, -1
    buffer_load_dwordx2 v[34:35], v51, s[44:47], s61 offen sc1
    buffer_load_dwordx4 v[144:147], v2, s[24:27], s59 offen offset:0 nt
    buffer_load_dwordx4 v[148:151], v2, s[24:27], s59 offen offset:1024 nt
    buffer_load_dwordx4 v[152:155], v2, s[24:27], s59 offen offset:2048 nt
    buffer_load_dwordx4 v[156:159], v2, s[24:27], s59 offen offset:3072 nt
    s_add_u32 s52, s52, 1
    s_branch L_PLOOP_E
L_RETRY_0_E:
    s_mov_b32 s59, 1000000
L_RETL_0_E:
    buffer_load_dwordx2 v[32:33], v51, s[8:11], s60 offen sc1
    s_waitcnt vmcnt(0)
    v_cmp_ne_u32 vcc, s12, v33
    s_cbranch_vccz L_RETB_0_E
    s_sub_u32 s59, s59, 1
    s_cmp_lg_u32 s59, 0
    s_cbranch_scc1 L_RETL_0_E
    s_branch L_RETB_0_E
L_RESC_0_E:
    v_mov_b32 v6, v32
    s_nop 7
    v_max_f32_dpp v6, v6, v6 row_shr:1 row_mask:0xf bank_mask:0xf
    s_nop 1
    v_max_f32_dpp v6, v6, v6 row_shr:2 row_mask:0xf bank_mask:0xf
    s_nop 1
    v_max_f32_dpp v6, v6, v6 row_shr:4 row_mask:0xf bank_mask:0xf
    s_nop 1
    v_max_f32_dpp v6, v6, v6 row_shr:8 row_mask:0xf bank_mask:0xf
    s_nop 1
    v_max_f32_dpp v6, v6, v6 row_bcast:15 row_mask:0xa bank_mask:0xf
    s_nop 1
    v_max_f32_dpp v6, v6, v6 row_bcast:31 row_mask:0xc bank_mask:0xf
    s_nop 0
    v_readlane_b32 s59, v6, 63
    v_mov_b32 v6, s38
    s_nop 0
    v_max_f32 v7, s59, v6
    v_sub_f32 v6, v6, v7
    v_mul_f32 v6, 0x3fb8aa3b, v6
    v_exp_f32 v6, v6
    v_readfirstlane_b32 s38, v7
    v_mul_f32 v12, v12, v6
    v_mul_f32 v13, v13, v6
    v_mul_f32 v14, v14, v6
    v_mul_f32 v15, v15, v6
    v_mul_f32 v5, v5, v6
    s_nop 4
    s_branch L_RESB_0_E
L_RETRY_1_E:
    s_mov_b32 s59, 1000000
L_RETL_1_E:
    buffer_load_dwordx2 v[34:35], v51, s[8:11], s61 offen sc1
    s_waitcnt vmcnt(0)
    v_cmp_ne_u32 vcc, s12, v35
    s_cbranch_vccz L_RETB_1_E
    s_sub_u32 s59, s59, 1
    s_cmp_lg_u32 s59, 0
    s_cbranch_scc1 L_RETL_1_E
    s_branch L_RETB_1_E
L_RESC_1_E:
    v_mov_b32 v6, v34
    s_nop 7
    v_max_f32_dpp v6, v6, v6 row_shr:1 row_mask:0xf bank_mask:0xf
    s_nop 1
    v_max_f32_dpp v6, v6, v6 row_shr:2 row_mask:0xf bank_mask:0xf
    s_nop 1
    v_max_f32_dpp v6, v6, v6 row_shr:4 row_mask:0xf bank_mask:0xf
    s_nop 1
    v_max_f32_dpp v6, v6, v6 row_shr:8 row_mask:0xf bank_mask:0xf
    s_nop 1
    v_max_f32_dpp v6, v6, v6 row_bcast:15 row_mask:0xa bank_mask:0xf
    s_nop 1
    v_max_f32_dpp v6, v6, v6 row_bcast:31 row_mask:0xc bank_mask:0xf
    s_nop 0
    v_readlane_b32 s59, v6, 63
    v_mov_b32 v6, s38
    s_nop 0
    v_max_f32 v7, s59, v6
    v_sub_f32 v6, v6, v7
    v_mul_f32 v6, 0x3fb8aa3b, v6
    v_exp_f32 v6, v6
    v_readfirstlane_b32 s38, v7
    v_mul_f32 v12, v12, v6
    v_mul_f32 v13, v13, v6
    v_mul_f32 v14, v14, v6
    v_mul_f32 v15, v15, v6
    v_mul_f32 v5, v5, v6
    s_nop 4
    s_branch L_RESB_1_E
L_VDONE_E:
    s_waitcnt vmcnt(0)
    v_add_f32_dpp v5, v5, v5 row_shr:1 row_mask:0xf bank_mask:0xf
    s_nop 1
    v_add_f32_dpp v5, v5, v5 row_shr:2 row_mask:0xf bank_mask:0xf
    s_nop 1
    v_add_f32_dpp v5, v5, v5 row_shr:4 row_mask:0xf bank_mask:0xf
    s_nop 1
    v_add_f32_dpp v5, v5, v5 row_shr:8 row_mask:0xf bank_mask:0xf
    s_nop 1
    v_add_f32_dpp v5, v5, v5 row_bcast:15 row_mask:0xa bank_mask:0xf
    s_nop 1
    v_add_f32_dpp v5, v5, v5 row_bcast:31 row_mask:0xc bank_mask:0xf
    s_nop 0
    v_readlane_b32 s59, v5, 63
    v_lshrrev_b32 v6, 4, v0
    v_lshlrev_b32 v6, 5, v6
    v_and_b32 v7, 7, v0
    v_add_u32 v6, v6, v7
    s_lshl_b32 s40, s29, 9
    s_add_u32 s40, s40, 24832
    v_lshl_add_u32 v6, v6, 2, s40
    ds_write_b32 v6, v12
    ds_write_b32 v6, v13 offset:32
    ds_write_b32 v6, v14 offset:64
    ds_write_b32 v6, v15 offset:96
    v_mov_b32 v8, s38
    v_mov_b32 v9, s59
    v_mul_f32 v9, 0.25, v9
    s_lshl_b32 s40, s29, 3
    s_add_u32 s40, s40, 26880
    v_mov_b32 v7, s40
    ds_write_b64 v7, v[8:9]
    s_waitcnt lgkmcnt(0)
    s_barrier
    s_endpgm
L_HELPER:
    s_setprio 1
    v_mov_b32 v31, 0
    v_lshrrev_b32 v4, 4, v0
    v_bfe_u32 v5, v0, 2, 2
    v_and_b32 v6, 3, v0
    v_lshl_add_u32 v7, v4, 3, v5
    s_mul_i32 s52, s3, 20480
    s_add_u32 s52, s52, 29952
    s_lshl_b32 s53, s3, 11
    s_add_u32 s53, s53, 16640
    v_lshl_add_u32 v2, v4, 4, s53
    v_lshl_add_u32 v3, v0, 2, s53
    v_lshrrev_b32 v8, 3, v0
    v_and_b32 v9, 7, v0
    v_lshlrev_b32 v9, 4, v9
    v_lshlrev_b32 v1, 7, v7
    v_lshl_add_u32 v1, v6, 3, v1
    v_add_u32 v1, s52, v1
    s_waitcnt lgkmcnt(0)
    s_mov_b32 s8, s42
    s_mov_b32 s9, s43
    s_mov_b32 s10, 6291456
    s_mov_b32 s11, 0x20000
    s_load_dword s12, s[42:43], 0
    s_cmp_lg_u32 s3, 0
    s_cbranch_scc1 L_NOZF
    v_mov_b32 v10, 0
    v_lshlrev_b32 v11, 2, v0
    ds_write_b32 v11, v10 offset:29312
    ds_write_b32 v11, v10 offset:29568
L_NOZF:
    s_cmp_lg_u32 s3, 2
    s_cbranch_scc1 L_PRE_NT
    s_cmp_lg_u32 s5, 20
    s_cbranch_scc1 L_PRE_NT
    s_getpc_b64 s[44:45]
L_PC:
    s_sub_u32 s44, s44, L_PC-KSTART
    s_subb_u32 s45, s45, 0
    s_mov_b32 s46, KEND-KSTART
    s_mov_b32 s47, 0x20000
    v_lshlrev_b32 v11, 4, v0
    s_mov_b32 s56, 0
L_PT:
    buffer_load_dwordx4 v[252:255], v11, s[44:47], s56 offen
    s_add_u32 s56, s56, 1024
    s_cmp_lt_u32 s56, KEND-KSTART
    s_cbranch_scc1 L_PT
L_PRE_NT:
    s_cmp_eq_u32 s6, 2
    s_cbranch_scc1 L_PRE_Q
    s_cmp_eq_u32 s6, 1
    s_cbranch_scc1 L_PRE_M
    s_cmp_eq_u32 s6, 3
    s_cbranch_scc1 L_PRE_F
    s_cmp_eq_u32 s6, 4
    s_cbranch_scc1 L_PRE_W
    s_branch L_PRE_NONE
L_PRE_M:
    s_mov_b32 s54, s7
    s_mov_b32 s48, s34
    s_mov_b32 s49, s35
    s_mov_b32 s50, 1280
    s_mov_b32 s51, 0x20000
    s_mul_i32 s56, s3, 320
    v_lshlrev_b32 v11, 2, v0
    buffer_load_dword v12, v11, s[48:51], s56 offen
    s_mov_b64 exec, 0xffff
    buffer_load_dword v13, v11, s[48:51], s56 offen offset:256
    s_mov_b64 exec, -1
    s_mov_b32 s44, s36
    s_mov_b32 s45, s37
    s_mov_b32 s46, 4915200
    s_mov_b32 s47, 0x20000
    v_mul_u32_u24 v10, 7680, v8
    v_bfe_u32 v11, v0, 4, 1
    v_lshlrev_b32 v11, 5, v11
    v_xor_b32 v11, v11, v9
    v_add_u32 v20, v10, v11
    v_xor_b32 v11, 64, v11
    v_add_u32 v21, v10, v11
    s_mul_i32 s57, s3, 1228800
    s_lshl_b32 s58, s54, 7
    s_add_u32 s57, s57, s58
    s_add_u32 m0, s52, 0
    s_nop 0
    buffer_load_dwordx4 v20, s[44:47], s57 offen nt lds
    s_add_u32 s57, s57, 61440
    s_add_u32 m0, s52, 1024
    s_nop 0
    buffer_load_dwordx4 v21, s[44:47], s57 offen nt lds
    s_add_u32 s57, s57, 61440
    s_add_u32 m0, s52, 2048
    s_nop 0
    buffer_load_dwordx4 v20, s[44:47], s57 offen nt lds
    s_add_u32 s57, s57, 61440
    s_add_u32 m0, s52, 3072
    s_nop 0
    buffer_load_dwordx4 v21, s[44:47], s57 offen nt lds
    s_add_u32 s57, s57, 61440
    s_add_u32 m0, s52, 4096
    s_nop 0
    buffer_load_dwordx4 v20, s[44:47], s57 offen nt lds
    s_add_u32 s57, s57, 61440
    s_add_u32 m0, s52, 5120
    s_nop 0
    buffer_load_dwordx4 v21, s[44:47], s57 offen nt lds
    s_add_u32 s57, s57, 61440
    s_add_u32 m0, s52, 6144
    s_nop 0
    buffer_load_dwordx4 v20, s[44:47], s57 offen nt lds
    s_add_u32 s57, s57, 61440
    s_add_u32 m0, s52, 7168
    s_nop 0
    buffer_load_dwordx4 v21, s[44:47], s57 offen nt lds
    s_add_u32 s57, s57, 61440
    s_add_u32 m0, s52, 8192
    s_nop 0
    buffer_load_dwordx4 v20, s[44:47], s57 offen nt lds
    s_add_u32 s57, s57, 61440
    s_add_u32 m0, s52, 9216
    s_nop 0
    buffer_load_dwordx4 v21, s[44:47], s57 offen nt lds
    s_add_u32 s57, s57, 61440
    s_add_u32 m0, s52, 10240
    s_nop 0
    buffer_load_dwordx4 v20, s[44:47], s57 offen nt lds
    s_add_u32 s57, s57, 61440
    s_add_u32 m0, s52, 11264
    s_nop 0
    buffer_load_dwordx4 v21, s[44:47], s57 offen nt lds
    s_add_u32 s57, s57, 61440
    s_add_u32 m0, s52, 12288
    s_nop 0
    buffer_load_dwordx4 v20, s[44:47], s57 offen nt lds
    s_add_u32 s57, s57, 61440
    s_add_u32 m0, s52, 13312
    s_nop 0
    buffer_load_dwordx4 v21, s[44:47], s57 offen nt lds
    s_add_u32 s57, s57, 61440
    s_add_u32 m0, s52, 14336
    s_nop 0
    buffer_load_dwordx4 v20, s[44:47], s57 offen nt lds
    s_add_u32 s57, s57, 61440
    s_add_u32 m0, s52, 15360
    s_nop 0
    buffer_load_dwordx4 v21, s[44:47], s57 offen nt lds
    s_add_u32 s57, s57, 61440
    s_add_u32 m0, s52, 16384
    s_nop 0
    buffer_load_dwordx4 v20, s[44:47], s57 offen nt lds
    s_add_u32 s57, s57, 61440
    s_add_u32 m0, s52, 17408
    s_nop 0
    buffer_load_dwordx4 v21, s[44:47], s57 offen nt lds
    s_add_u32 s57, s57, 61440
    s_add_u32 m0, s52, 18432
    s_nop 0
    buffer_load_dwordx4 v20, s[44:47], s57 offen nt lds
    s_add_u32 s57, s57, 61440
    s_add_u32 m0, s52, 19456
    s_nop 0
    buffer_load_dwordx4 v21, s[44:47], s57 offen nt lds
    s_waitcnt lgkmcnt(0)
    s_mul_i32 s12, s12, 1664525
    s_add_u32 s12, s12, 1013904223
    v_mov_b32 v27, s12
    s_waitcnt vmcnt(20)
    v_lshlrev_b32 v20, 16, v12
    v_and_b32 v21, 0xffff0000, v12
    v_mul_f32 v22, 0xbfb8aa3b, v20
    v_min_f32 v22, 0x42fc0000, v22
    v_exp_f32 v22, v22
    s_nop 0
    v_add_f32 v22, 1.0, v22
    v_rcp_f32 v23, v22
    s_nop 0
    v_mul_f32 v24, v20, v23
    v_fma_f32 v25, -v24, v22, v20
    v_fma_f32 v20, v25, v23, v24
    v_mul_f32 v22, 0xbfb8aa3b, v21
    v_min_f32 v22, 0x42fc0000, v22
    v_exp_f32 v22, v22
    s_nop 0
    v_add_f32 v22, 1.0, v22
    v_rcp_f32 v23, v22
    s_nop 0
    v_mul_f32 v24, v21, v23
    v_fma_f32 v25, -v24, v22, v21
    v_fma_f32 v21, v25, v23, v24
    v_cvt_pk_bf16_f32 v20, v20, v21
    ds_write_b32 v3, v20 offset:0
    v_lshlrev_b32 v20, 16, v13
    v_and_b32 v21, 0xffff0000, v13
    v_mul_f32 v22, 0xbfb8aa3b, v20
    v_min_f32 v22, 0x42fc0000, v22
    v_exp_f32 v22, v22
    s_nop 0
    v_add_f32 v22, 1.0, v22
    v_rcp_f32 v23, v22
    s_nop 0
    v_mul_f32 v24, v20, v23
    v_fma_f32 v25, -v24, v22, v20
    v_fma_f32 v20, v25, v23, v24
    v_mul_f32 v22, 0xbfb8aa3b, v21
    v_min_f32 v22, 0x42fc0000, v22
    v_exp_f32 v22, v22
    s_nop 0
    v_add_f32 v22, 1.0, v22
    v_rcp_f32 v23, v22
    s_nop 0
    v_mul_f32 v24, v21, v23
    v_fma_f32 v25, -v24, v22, v21
    v_fma_f32 v21, v25, v23, v24
    v_cvt_pk_bf16_f32 v20, v20, v21
    ds_write_b32 v3, v20 offset:256
    s_waitcnt vmcnt(0)
    s_waitcnt lgkmcnt(0)
    s_barrier
    v_bfe_u32 v16, v0, 3, 1
    v_lshlrev_b32 v16, 1, v16
    v_and_b32 v17, 1, v4
    v_lshl_or_b32 v16, v17, 2, v16
    v_lshrrev_b32 v17, 1, v6
    v_and_b32 v18, 1, v6
    v_lshlrev_b32 v18, 3, v18
    v_lshl_add_u32 v18, v7, 7, v18
    v_add_u32 v18, s52, v18
    v_add_u32 v19, 0, v17
    v_xor_b32 v19, v19, v16
    v_lshl_add_u32 v12, v19, 4, v18
    v_add_u32 v19, 2, v17
    v_xor_b32 v19, v19, v16
    v_lshl_add_u32 v13, v19, 4, v18
    v_add_u32 v19, 4, v17
    v_xor_b32 v19, v19, v16
    v_lshl_add_u32 v14, v19, 4, v18
    v_add_u32 v19, 6, v17
    v_xor_b32 v19, v19, v16
    v_lshl_add_u32 v15, v19, 4, v18
    ds_read_b64_tr_b16 v[112:113], v12 offset:0
    ds_read_b64_tr_b16 v[114:115], v12 offset:512
    ds_read_b64_tr_b16 v[116:117], v12 offset:4096
    ds_read_b64_tr_b16 v[118:119], v12 offset:4608
    ds_read_b64_tr_b16 v[120:121], v12 offset:8192
    ds_read_b64_tr_b16 v[122:123], v12 offset:8704
    ds_read_b64_tr_b16 v[124:125], v12 offset:12288
    ds_read_b64_tr_b16 v[126:127], v12 offset:12800
    ds_read_b64_tr_b16 v[128:129], v12 offset:16384
    ds_read_b64_tr_b16 v[130:131], v12 offset:16896
    ds_read_b64_tr_b16 v[132:133], v13 offset:0
    ds_read_b64_tr_b16 v[134:135], v13 offset:512
    ds_read_b64_tr_b16 v[136:137], v13 offset:4096
    ds_read_b64_tr_b16 v[138:139], v13 offset:4608
    ds_read_b64_tr_b16 v[140:141], v13 offset:8192
    ds_read_b64_tr_b16 v[142:143], v13 offset:8704
    ds_read_b64_tr_b16 v[144:145], v13 offset:12288
    ds_read_b64_tr_b16 v[146:147], v13 offset:12800
    ds_read_b64_tr_b16 v[148:149], v13 offset:16384
    ds_read_b64_tr_b16 v[150:151], v13 offset:16896
    ds_read_b64_tr_b16 v[152:153], v14 offset:0
    ds_read_b64_tr_b16 v[154:155], v14 offset:512
    ds_read_b64_tr_b16 v[156:157], v14 offset:4096
    ds_read_b64_tr_b16 v[158:159], v14 offset:4608
    ds_read_b64_tr_b16 v[160:161], v14 offset:8192
    ds_read_b64_tr_b16 v[162:163], v14 offset:8704
    ds_read_b64_tr_b16 v[164:165], v14 offset:12288
    ds_read_b64_tr_b16 v[166:167], v14 offset:12800
    ds_read_b64_tr_b16 v[168:169], v14 offset:16384
    ds_read_b64_tr_b16 v[170:171], v14 offset:16896
    ds_read_b64_tr_b16 v[172:173], v15 offset:0
    ds_read_b64_tr_b16 v[174:175], v15 offset:512
    ds_read_b64_tr_b16 v[176:177], v15 offset:4096
    ds_read_b64_tr_b16 v[178:179], v15 offset:4608
    ds_read_b64_tr_b16 v[180:181], v15 offset:8192
    ds_read_b64_tr_b16 v[182:183], v15 offset:8704
    ds_read_b64_tr_b16 v[184:185], v15 offset:12288
    ds_read_b64_tr_b16 v[186:187], v15 offset:12800
    ds_read_b64_tr_b16 v[188:189], v15 offset:16384
    ds_read_b64_tr_b16 v[190:191], v15 offset:16896
    s_waitcnt lgkmcnt(0)
    ds_read_b128 v[32:35], v2 offset:0
    ds_read_b128 v[36:39], v2 offset:64
    ds_read_b128 v[40:43], v2 offset:128
    ds_read_b128 v[44:47], v2 offset:192
    ds_read_b128 v[48:51], v2 offset:256
    s_waitcnt lgkmcnt(4)
    v_mfma_f32_16x16x32_bf16 v[192:195], v[32:35], v[112:115], 0
    v_mfma_f32_16x16x32_bf16 v[196:199], v[32:35], v[132:135], 0
    v_mfma_f32_16x16x32_bf16 v[200:203], v[32:35], v[152:155], 0
    v_mfma_f32_16x16x32_bf16 v[204:207], v[32:35], v[172:175], 0
    s_waitcnt lgkmcnt(3)
    v_mfma_f32_16x16x32_bf16 v[192:195], v[36:39], v[116:119], v[192:195]
    v_mfma_f32_16x16x32_bf16 v[196:199], v[36:39], v[136:139], v[196:199]
    v_mfma_f32_16x16x32_bf16 v[200:203], v[36:39], v[156:159], v[200:203]
    v_mfma_f32_16x16x32_bf16 v[204:207], v[36:39], v[176:179], v[204:207]
    s_waitcnt lgkmcnt(2)
    v_mfma_f32_16x16x32_bf16 v[192:195], v[40:43], v[120:123], v[192:195]
    v_mfma_f32_16x16x32_bf16 v[196:199], v[40:43], v[140:143], v[196:199]
    v_mfma_f32_16x16x32_bf16 v[200:203], v[40:43], v[160:163], v[200:203]
    v_mfma_f32_16x16x32_bf16 v[204:207], v[40:43], v[180:183], v[204:207]
    s_waitcnt lgkmcnt(1)
    v_mfma_f32_16x16x32_bf16 v[192:195], v[44:47], v[124:127], v[192:195]
    v_mfma_f32_16x16x32_bf16 v[196:199], v[44:47], v[144:147], v[196:199]
    v_mfma_f32_16x16x32_bf16 v[200:203], v[44:47], v[164:167], v[200:203]
    v_mfma_f32_16x16x32_bf16 v[204:207], v[44:47], v[184:187], v[204:207]
    s_waitcnt lgkmcnt(0)
    v_mfma_f32_16x16x32_bf16 v[192:195], v[48:51], v[128:131], v[192:195]
    v_mfma_f32_16x16x32_bf16 v[196:199], v[48:51], v[148:151], v[196:199]
    v_mfma_f32_16x16x32_bf16 v[200:203], v[48:51], v[168:171], v[200:203]
    v_mfma_f32_16x16x32_bf16 v[204:207], v[48:51], v[188:191], v[204:207]
    v_cmp_eq_u32 s[56:57], 1, v4
    v_cmp_eq_u32 s[58:59], 2, v4
    v_cmp_eq_u32 s[60:61], 3, v4
    s_nop 2
    v_cndmask_b32_e64 v16, v192, v196, s[56:57]
    v_cndmask_b32_e64 v16, v16, v200, s[58:59]
    v_cndmask_b32_e64 v16, v16, v204, s[60:61]
    s_lshl_b32 s56, s3, 8
    v_lshl_add_u32 v17, v0, 2, s56
    ds_write_b32 v17, v16 offset:26944
    s_waitcnt lgkmcnt(0)
    s_lshl_b32 s91, s3, 2
    s_add_u32 s91, s91, 29328
    v_mov_b32 v28, s91
    v_mov_b32 v29, s12
    ds_write_b32 v28, v29
    v_mov_b32 v24, 29328
    s_mov_b32 s91, 8000000
L_FW_M_21:
    ds_read_b128 v[20:23], v24
    s_waitcnt lgkmcnt(0)
    v_xor_b32 v20, s12, v20
    v_bitop3_b32 v20, v20, v21, s12 bitop3:0xf6
    v_bitop3_b32 v20, v20, v22, s12 bitop3:0xf6
    v_bitop3_b32 v20, v20, v23, s12 bitop3:0xf6
    v_cmp_ne_u32 vcc, 0, v20
    s_cbranch_vccz L_FD_M_22
    s_sub_u32 s91, s91, 1
    s_cmp_lg_u32 s91, 0
    s_cbranch_scc1 L_FW_M_21
L_FD_M_22:
    v_lshlrev_b32 v17, 2, v0
    ds_read_b32 v16, v17 offset:26944
    ds_read_b32 v18, v17 offset:27200
    ds_read_b32 v19, v17 offset:27456
    ds_read_b32 v20, v17 offset:27712
    s_waitcnt lgkmcnt(0)
    v_add_f32 v16, v16, v18
    v_add_f32 v19, v19, v20
    v_add_f32 v16, v16, v19
    s_cmp_lg_u32 s3, 0
    s_cbranch_scc1 L_PRE_QG
    s_mul_i32 s58, s54, 26
    s_lshr_b32 s58, s58, 8
    s_mul_i32 s59, s58, 10
    s_sub_u32 s59, s54, s59
    s_lshl_b32 s59, s59, 5
    s_mov_b32 s60, 4096
    s_mov_b32 s61, 4
    s_cmp_eq_u32 s58, 1
    s_cselect_b32 s60, 4104, s60
    s_cmp_eq_u32 s58, 2
    s_cselect_b32 s60, 20480, s60
    s_cselect_b32 s61, 3, s61
    s_cmp_eq_u32 s58, 3
    s_cselect_b32 s60, 12288, s60
    s_cmp_eq_u32 s58, 4
    s_cselect_b32 s60, 12296, s60
    s_cmp_eq_u32 s58, 5
    s_cselect_b32 s60, 24576, s60
    s_cselect_b32 s61, 3, s61
    s_lshl_b32 s59, s59, s61
    s_add_u32 s60, s60, s59
    v_lshrrev_b32 v21, 1, v0
    v_lshlrev_b32 v21, s61, v21
    v_mov_b32_dpp v20, v16 quad_perm:[1,1,3,3] row_mask:0xf bank_mask:0xf
    v_cvt_pk_bf16_f32 v26, v16, v20
    s_mov_b32 s56, 0x55555555
    s_mov_b32 s57, 0x55555555
    s_mov_b64 exec, s[56:57]
    buffer_store_dwordx2 v[26:27], v21, s[8:11], s60 offen sc1
    s_mov_b64 exec, -1
    s_branch L_PRE_QG
L_PRE_Q:
    s_mov_b32 s48, s16
    s_mov_b32 s49, s17
    s_mov_b32 s50, 1280
    s_mov_b32 s51, 0x20000
    v_lshlrev_b32 v11, 2, v0
    buffer_load_dword v12, v11, s[48:51], 0 offen offset:0
    buffer_load_dword v13, v11, s[48:51], 0 offen offset:256
    buffer_load_dword v14, v11, s[48:51], 0 offen offset:512
    buffer_load_dword v15, v11, s[48:51], 0 offen offset:768
    buffer_load_dword v16, v11, s[48:51], 0 offen offset:1024
    s_mul_i32 s56, s3, 320
    buffer_load_dword v18, v11, s[48:51], s56 offen
    v_mov_b32 v19, 0
    s_mov_b64 exec, 0xffff
    buffer_load_dword v19, v11, s[48:51], s56 offen offset:256
    s_mov_b64 exec, -1
    s_mov_b32 s44, s22
    s_mov_b32 s45, s23
    s_mov_b32 s46, 5242880
    s_mov_b32 s47, 0x20000
    v_mul_u32_u24 v10, 8192, v8
    v_bfe_u32 v11, v0, 4, 1
    v_lshlrev_b32 v11, 5, v11
    v_xor_b32 v11, v11, v9
    v_add_u32 v20, v10, v11
    v_xor_b32 v11, 64, v11
    v_add_u32 v21, v10, v11
    s_mul_i32 s57, s3, 1310720
    s_lshl_b32 s58, s7, 7
    s_add_u32 s57, s57, s58
    s_add_u32 m0, s52, 0
    s_nop 0
    buffer_load_dwordx4 v20, s[44:47], s57 offen nt lds
    s_add_u32 s57, s57, 65536
    s_add_u32 m0, s52, 1024
    s_nop 0
    buffer_load_dwordx4 v21, s[44:47], s57 offen nt lds
    s_add_u32 s57, s57, 65536
    s_add_u32 m0, s52, 2048
    s_nop 0
    buffer_load_dwordx4 v20, s[44:47], s57 offen nt lds
    s_add_u32 s57, s57, 65536
    s_add_u32 m0, s52, 3072
    s_nop 0
    buffer_load_dwordx4 v21, s[44:47], s57 offen nt lds
    s_add_u32 s57, s57, 65536
    s_add_u32 m0, s52, 4096
    s_nop 0
    buffer_load_dwordx4 v20, s[44:47], s57 offen nt lds
    s_add_u32 s57, s57, 65536
    s_add_u32 m0, s52, 5120
    s_nop 0
    buffer_load_dwordx4 v21, s[44:47], s57 offen nt lds
    s_add_u32 s57, s57, 65536
    s_add_u32 m0, s52, 6144
    s_nop 0
    buffer_load_dwordx4 v20, s[44:47], s57 offen nt lds
    s_add_u32 s57, s57, 65536
    s_add_u32 m0, s52, 7168
    s_nop 0
    buffer_load_dwordx4 v21, s[44:47], s57 offen nt lds
    s_add_u32 s57, s57, 65536
    s_add_u32 m0, s52, 8192
    s_nop 0
    buffer_load_dwordx4 v20, s[44:47], s57 offen nt lds
    s_add_u32 s57, s57, 65536
    s_add_u32 m0, s52, 9216
    s_nop 0
    buffer_load_dwordx4 v21, s[44:47], s57 offen nt lds
    s_add_u32 s57, s57, 65536
    s_add_u32 m0, s52, 10240
    s_nop 0
    buffer_load_dwordx4 v20, s[44:47], s57 offen nt lds
    s_add_u32 s57, s57, 65536
    s_add_u32 m0, s52, 11264
    s_nop 0
    buffer_load_dwordx4 v21, s[44:47], s57 offen nt lds
    s_add_u32 s57, s57, 65536
    s_add_u32 m0, s52, 12288
    s_nop 0
    buffer_load_dwordx4 v20, s[44:47], s57 offen nt lds
    s_add_u32 s57, s57, 65536
    s_add_u32 m0, s52, 13312
    s_nop 0
    buffer_load_dwordx4 v21, s[44:47], s57 offen nt lds
    s_add_u32 s57, s57, 65536
    s_add_u32 m0, s52, 14336
    s_nop 0
    buffer_load_dwordx4 v20, s[44:47], s57 offen nt lds
    s_add_u32 s57, s57, 65536
    s_add_u32 m0, s52, 15360
    s_nop 0
    buffer_load_dwordx4 v21, s[44:47], s57 offen nt lds
    s_add_u32 s57, s57, 65536
    s_add_u32 m0, s52, 16384
    s_nop 0
    buffer_load_dwordx4 v20, s[44:47], s57 offen nt lds
    s_add_u32 s57, s57, 65536
    s_add_u32 m0, s52, 17408
    s_nop 0
    buffer_load_dwordx4 v21, s[44:47], s57 offen nt lds
    s_add_u32 s57, s57, 65536
    s_add_u32 m0, s52, 18432
    s_nop 0
    buffer_load_dwordx4 v20, s[44:47], s57 offen nt lds
    s_add_u32 s57, s57, 65536
    s_add_u32 m0, s52, 19456
    s_nop 0
    buffer_load_dwordx4 v21, s[44:47], s57 offen nt lds
    s_waitcnt lgkmcnt(0)
    s_barrier
    s_waitcnt lgkmcnt(0)
    s_mul_i32 s12, s12, 1664525
    s_add_u32 s12, s12, 1013904223
    v_mov_b32 v27, s12
    s_and_b32 s58, s7, 1
    s_or_b32 s58, s58, s3
    s_cmp_lg_u32 s58, 0
    s_cbranch_scc1 L_Q_NOZ
    s_lshr_b32 s58, s7, 1
    s_lshl_b32 s58, s58, 8
    s_add_u32 s58, s58, 65536
    v_mov_b32 v20, 0
    s_mov_b64 exec, 1
    buffer_store_dword v20, v20, s[8:11], s58 offen sc1
    s_mov_b64 exec, -1
L_Q_NOZ:
    s_waitcnt vmcnt(20)
    v_lshlrev_b32 v40, 16, v12
    v_and_b32 v41, 0xffff0000, v12
    v_lshlrev_b32 v42, 16, v13
    v_and_b32 v43, 0xffff0000, v13
    v_lshlrev_b32 v44, 16, v14
    v_and_b32 v45, 0xffff0000, v14
    v_lshlrev_b32 v46, 16, v15
    v_and_b32 v47, 0xffff0000, v15
    v_lshlrev_b32 v48, 16, v16
    v_and_b32 v49, 0xffff0000, v16
    v_add_f32 v20, v40, v41
    v_add_f32 v20, v20, v42
    v_add_f32 v20, v20, v43
    v_add_f32 v20, v20, v44
    v_add_f32 v20, v20, v45
    v_add_f32 v20, v20, v46
    v_add_f32 v20, v20, v47
    v_add_f32 v20, v20, v48
    v_add_f32 v20, v20, v49
    s_nop 1
    v_add_f32_dpp v20, v20, v20 row_shr:1 row_mask:0xf bank_mask:0xf
    s_nop 1
    v_add_f32_dpp v20, v20, v20 row_shr:2 row_mask:0xf bank_mask:0xf
    s_nop 1
    v_add_f32_dpp v20, v20, v20 row_shr:4 row_mask:0xf bank_mask:0xf
    s_nop 1
    v_add_f32_dpp v20, v20, v20 row_shr:8 row_mask:0xf bank_mask:0xf
    s_nop 1
    v_add_f32_dpp v20, v20, v20 row_bcast:15 row_mask:0xa bank_mask:0xf
    s_nop 1
    v_add_f32_dpp v20, v20, v20 row_bcast:31 row_mask:0xc bank_mask:0xf
    s_nop 0
    v_readlane_b32 s60, v20, 63
    s_nop 1
    v_mov_b32 v20, s60
    v_mul_f32 v20, 0x3acccccd, v20
    v_sub_f32 v21, v40, v20
    v_mul_f32 v22, v21, v21
    v_sub_f32 v21, v41, v20
    v_fmac_f32 v22, v21, v21
    v_sub_f32 v21, v42, v20
    v_fmac_f32 v22, v21, v21
    v_sub_f32 v21, v43, v20
    v_fmac_f32 v22, v21, v21
    v_sub_f32 v21, v44, v20
    v_fmac_f32 v22, v21, v21
    v_sub_f32 v21, v45, v20
    v_fmac_f32 v22, v21, v21
    v_sub_f32 v21, v46, v20
    v_fmac_f32 v22, v21, v21
    v_sub_f32 v21, v47, v20
    v_fmac_f32 v22, v21, v21
    v_sub_f32 v21, v48, v20
    v_fmac_f32 v22, v21, v21
    v_sub_f32 v21, v49, v20
    v_fmac_f32 v22, v21, v21
    s_nop 1
    v_add_f32_dpp v22, v22, v22 row_shr:1 row_mask:0xf bank_mask:0xf
    s_nop 1
    v_add_f32_dpp v22, v22, v22 row_shr:2 row_mask:0xf bank_mask:0xf
    s_nop 1
    v_add_f32_dpp v22, v22, v22 row_shr:4 row_mask:0xf bank_mask:0xf
    s_nop 1
    v_add_f32_dpp v22, v22, v22 row_shr:8 row_mask:0xf bank_mask:0xf
    s_nop 1
    v_add_f32_dpp v22, v22, v22 row_bcast:15 row_mask:0xa bank_mask:0xf
    s_nop 1
    v_add_f32_dpp v22, v22, v22 row_bcast:31 row_mask:0xc bank_mask:0xf
    s_nop 0
    v_readlane_b32 s61, v22, 63
    s_nop 1
    v_mov_b32 v22, s61
    v_mul_f32 v22, 0x3acccccd, v22
    v_cvt_pk_bf16_f32 v20, v20, v20
    v_and_b32 v20, 0xffff0000, v20
    v_cvt_pk_bf16_f32 v22, v22, v22
    v_and_b32 v22, 0xffff0000, v22
    v_add_f32 v22, 0x3727c5ac, v22
    v_cvt_pk_bf16_f32 v22, v22, v22
    v_and_b32 v22, 0xffff0000, v22
    v_sqrt_f32 v22, v22
    s_nop 0
    v_cvt_pk_bf16_f32 v22, v22, v22
    v_and_b32 v22, 0xffff0000, v22
    v_rcp_f32 v23, v22
    v_lshlrev_b32 v40, 16, v18
    v_and_b32 v41, 0xffff0000, v18
    v_lshlrev_b32 v42, 16, v19
    v_and_b32 v43, 0xffff0000, v19
    v_sub_f32 v40, v40, v20
    v_cvt_pk_bf16_f32 v40, v40, v40
    v_and_b32 v40, 0xffff0000, v40
    v_mul_f32 v21, v40, v23
    v_fma_f32 v40, -v21, v22, v40
    v_fma_f32 v40, v40, v23, v21
    v_cvt_pk_bf16_f32 v40, v40, v40
    v_and_b32 v40, 0xffff0000, v40
    v_sub_f32 v41, v41, v20
    v_cvt_pk_bf16_f32 v41, v41, v41
    v_and_b32 v41, 0xffff0000, v41
    v_mul_f32 v21, v41, v23
    v_fma_f32 v41, -v21, v22, v41
    v_fma_f32 v41, v41, v23, v21
    v_cvt_pk_bf16_f32 v41, v41, v41
    v_and_b32 v41, 0xffff0000, v41
    v_sub_f32 v42, v42, v20
    v_cvt_pk_bf16_f32 v42, v42, v42
    v_and_b32 v42, 0xffff0000, v42
    v_mul_f32 v21, v42, v23
    v_fma_f32 v42, -v21, v22, v42
    v_fma_f32 v42, v42, v23, v21
    v_cvt_pk_bf16_f32 v42, v42, v42
    v_and_b32 v42, 0xffff0000, v42
    v_sub_f32 v43, v43, v20
    v_cvt_pk_bf16_f32 v43, v43, v43
    v_and_b32 v43, 0xffff0000, v43
    v_mul_f32 v21, v43, v23
    v_fma_f32 v43, -v21, v22, v43
    v_fma_f32 v43, v43, v23, v21
    v_cvt_pk_bf16_f32 v43, v43, v43
    v_and_b32 v43, 0xffff0000, v43
    s_waitcnt vmcnt(0)
    v_bfe_u32 v16, v0, 3, 1
    v_lshlrev_b32 v16, 1, v16
    v_and_b32 v17, 1, v4
    v_lshl_or_b32 v16, v17, 2, v16
    v_lshrrev_b32 v17, 1, v6
    v_and_b32 v18, 1, v6
    v_lshlrev_b32 v18, 3, v18
    v_lshl_add_u32 v18, v7, 7, v18
    v_add_u32 v18, s52, v18
    v_add_u32 v19, 0, v17
    v_xor_b32 v19, v19, v16
    v_lshl_add_u32 v12, v19, 4, v18
    v_add_u32 v19, 2, v17
    v_xor_b32 v19, v19, v16
    v_lshl_add_u32 v13, v19, 4, v18
    v_add_u32 v19, 4, v17
    v_xor_b32 v19, v19, v16
    v_lshl_add_u32 v14, v19, 4, v18
    v_add_u32 v19, 6, v17
    v_xor_b32 v19, v19, v16
    v_lshl_add_u32 v15, v19, 4, v18
    ds_read_b64_tr_b16 v[112:113], v12 offset:0
    ds_read_b64_tr_b16 v[114:115], v12 offset:512
    ds_read_b64_tr_b16 v[116:117], v12 offset:4096
    ds_read_b64_tr_b16 v[118:119], v12 offset:4608
    ds_read_b64_tr_b16 v[120:121], v12 offset:8192
    ds_read_b64_tr_b16 v[122:123], v12 offset:8704
    ds_read_b64_tr_b16 v[124:125], v12 offset:12288
    ds_read_b64_tr_b16 v[126:127], v12 offset:12800
    ds_read_b64_tr_b16 v[128:129], v12 offset:16384
    ds_read_b64_tr_b16 v[130:131], v12 offset:16896
    ds_read_b64_tr_b16 v[132:133], v13 offset:0
    ds_read_b64_tr_b16 v[134:135], v13 offset:512
    ds_read_b64_tr_b16 v[136:137], v13 offset:4096
    ds_read_b64_tr_b16 v[138:139], v13 offset:4608
    ds_read_b64_tr_b16 v[140:141], v13 offset:8192
    ds_read_b64_tr_b16 v[142:143], v13 offset:8704
    ds_read_b64_tr_b16 v[144:145], v13 offset:12288
    ds_read_b64_tr_b16 v[146:147], v13 offset:12800
    ds_read_b64_tr_b16 v[148:149], v13 offset:16384
    ds_read_b64_tr_b16 v[150:151], v13 offset:16896
    ds_read_b64_tr_b16 v[152:153], v14 offset:0
    ds_read_b64_tr_b16 v[154:155], v14 offset:512
    ds_read_b64_tr_b16 v[156:157], v14 offset:4096
    ds_read_b64_tr_b16 v[158:159], v14 offset:4608
    ds_read_b64_tr_b16 v[160:161], v14 offset:8192
    ds_read_b64_tr_b16 v[162:163], v14 offset:8704
    ds_read_b64_tr_b16 v[164:165], v14 offset:12288
    ds_read_b64_tr_b16 v[166:167], v14 offset:12800
    ds_read_b64_tr_b16 v[168:169], v14 offset:16384
    ds_read_b64_tr_b16 v[170:171], v14 offset:16896
    ds_read_b64_tr_b16 v[172:173], v15 offset:0
    ds_read_b64_tr_b16 v[174:175], v15 offset:512
    ds_read_b64_tr_b16 v[176:177], v15 offset:4096
    ds_read_b64_tr_b16 v[178:179], v15 offset:4608
    ds_read_b64_tr_b16 v[180:181], v15 offset:8192
    ds_read_b64_tr_b16 v[182:183], v15 offset:8704
    ds_read_b64_tr_b16 v[184:185], v15 offset:12288
    ds_read_b64_tr_b16 v[186:187], v15 offset:12800
    ds_read_b64_tr_b16 v[188:189], v15 offset:16384
    ds_read_b64_tr_b16 v[190:191], v15 offset:16896
    v_lshlrev_b32 v11, 4, v0
    s_mul_i32 s62, s3, 1280
    s_add_u32 s62, s62, 4096
    v_mov_b32 v196, 0
    v_mov_b32 v198, 0
    s_mov_b32 s90, 1000000
L_POLL_M_23:
    buffer_load_dwordx4 v[192:195], v11, s[8:11], s62 offen sc1
    s_mov_b64 exec, 0xffff
    buffer_load_dwordx4 v[196:199], v11, s[8:11], s62 offen offset:1024 sc1
    s_mov_b64 exec, -1
    s_waitcnt vmcnt(0)
    v_mov_b32 v29, 0
    v_bitop3_b32 v29, v29, v193, s12 bitop3:0xf6
    v_bitop3_b32 v29, v29, v195, s12 bitop3:0xf6
    s_mov_b64 exec, 0xffff
    v_bitop3_b32 v29, v29, v197, s12 bitop3:0xf6
    v_bitop3_b32 v29, v29, v199, s12 bitop3:0xf6
    s_mov_b64 exec, -1
    v_cmp_ne_u32 vcc, 0, v29
    s_cbranch_vccz L_POLLD_M_24
    s_sleep 1
    s_sub_u32 s90, s90, 1
    s_cmp_lg_u32 s90, 0
    s_cbranch_scc1 L_POLL_M_23
    s_mov_b32 s92, s40
    s_mov_b32 s93, s41
    s_mov_b32 s94, 256
    s_mov_b32 s95, 0x20000
    v_mov_b32 v28, 1
    v_mov_b32 v29, 4
    buffer_store_dword v28, v29, s[92:95], 0 offen
L_POLLD_M_24:
    v_lshlrev_b32 v20, 16, v194
    v_and_b32 v21, 0xffff0000, v194
    v_lshlrev_b32 v22, 16, v192
    v_and_b32 v23, 0xffff0000, v192
    v_add_f32 v20, 1.0, v20
    v_cvt_pk_bf16_f32 v20, v20, v20
    v_and_b32 v20, 0xffff0000, v20
    v_mul_f32 v20, v40, v20
    v_cvt_pk_bf16_f32 v20, v20, v20
    v_and_b32 v20, 0xffff0000, v20
    v_add_f32 v20, v20, v22
    v_add_f32 v21, 1.0, v21
    v_cvt_pk_bf16_f32 v21, v21, v21
    v_and_b32 v21, 0xffff0000, v21
    v_mul_f32 v21, v41, v21
    v_cvt_pk_bf16_f32 v21, v21, v21
    v_and_b32 v21, 0xffff0000, v21
    v_add_f32 v21, v21, v23
    v_cvt_pk_bf16_f32 v20, v20, v21
    ds_write_b32 v3, v20 offset:0
    v_lshlrev_b32 v20, 16, v198
    v_and_b32 v21, 0xffff0000, v198
    v_lshlrev_b32 v22, 16, v196
    v_and_b32 v23, 0xffff0000, v196
    v_add_f32 v20, 1.0, v20
    v_cvt_pk_bf16_f32 v20, v20, v20
    v_and_b32 v20, 0xffff0000, v20
    v_mul_f32 v20, v42, v20
    v_cvt_pk_bf16_f32 v20, v20, v20
    v_and_b32 v20, 0xffff0000, v20
    v_add_f32 v20, v20, v22
    v_add_f32 v21, 1.0, v21
    v_cvt_pk_bf16_f32 v21, v21, v21
    v_and_b32 v21, 0xffff0000, v21
    v_mul_f32 v21, v43, v21
    v_cvt_pk_bf16_f32 v21, v21, v21
    v_and_b32 v21, 0xffff0000, v21
    v_add_f32 v21, v21, v23
    v_cvt_pk_bf16_f32 v20, v20, v21
    ds_write_b32 v3, v20 offset:256
    s_waitcnt lgkmcnt(0)
    ds_read_b128 v[32:35], v2 offset:0
    ds_read_b128 v[36:39], v2 offset:64
    ds_read_b128 v[40:43], v2 offset:128
    ds_read_b128 v[44:47], v2 offset:192
    ds_read_b128 v[48:51], v2 offset:256
    s_waitcnt lgkmcnt(4)
    v_mfma_f32_16x16x32_bf16 v[208:211], v[32:35], v[112:115], 0
    v_mfma_f32_16x16x32_bf16 v[212:215], v[32:35], v[132:135], 0
    v_mfma_f32_16x16x32_bf16 v[216:219], v[32:35], v[152:155], 0
    v_mfma_f32_16x16x32_bf16 v[220:223], v[32:35], v[172:175], 0
    s_waitcnt lgkmcnt(3)
    v_mfma_f32_16x16x32_bf16 v[208:211], v[36:39], v[116:119], v[208:211]
    v_mfma_f32_16x16x32_bf16 v[212:215], v[36:39], v[136:139], v[212:215]
    v_mfma_f32_16x16x32_bf16 v[216:219], v[36:39], v[156:159], v[216:219]
    v_mfma_f32_16x16x32_bf16 v[220:223], v[36:39], v[176:179], v[220:223]
    s_waitcnt lgkmcnt(2)
    v_mfma_f32_16x16x32_bf16 v[208:211], v[40:43], v[120:123], v[208:211]
    v_mfma_f32_16x16x32_bf16 v[212:215], v[40:43], v[140:143], v[212:215]
    v_mfma_f32_16x16x32_bf16 v[216:219], v[40:43], v[160:163], v[216:219]
    v_mfma_f32_16x16x32_bf16 v[220:223], v[40:43], v[180:183], v[220:223]
    s_waitcnt lgkmcnt(1)
    v_mfma_f32_16x16x32_bf16 v[208:211], v[44:47], v[124:127], v[208:211]
    v_mfma_f32_16x16x32_bf16 v[212:215], v[44:47], v[144:147], v[212:215]
    v_mfma_f32_16x16x32_bf16 v[216:219], v[44:47], v[164:167], v[216:219]
    v_mfma_f32_16x16x32_bf16 v[220:223], v[44:47], v[184:187], v[220:223]
    s_waitcnt lgkmcnt(0)
    v_mfma_f32_16x16x32_bf16 v[208:211], v[48:51], v[128:131], v[208:211]
    v_mfma_f32_16x16x32_bf16 v[212:215], v[48:51], v[148:151], v[212:215]
    v_mfma_f32_16x16x32_bf16 v[216:219], v[48:51], v[168:171], v[216:219]
    v_mfma_f32_16x16x32_bf16 v[220:223], v[48:51], v[188:191], v[220:223]
    v_cmp_eq_u32 s[56:57], 1, v4
    v_cmp_eq_u32 s[58:59], 2, v4
    v_cmp_eq_u32 s[60:61], 3, v4
    s_nop 2
    v_cndmask_b32_e64 v16, v208, v212, s[56:57]
    v_cndmask_b32_e64 v16, v16, v216, s[58:59]
    v_cndmask_b32_e64 v16, v16, v220, s[60:61]
    s_lshl_b32 s56, s3, 8
    v_lshl_add_u32 v17, v0, 2, s56
    ds_write_b32 v17, v16 offset:26944
    s_waitcnt lgkmcnt(0)
    s_lshl_b32 s91, s3, 2
    s_add_u32 s91, s91, 29328
    v_mov_b32 v28, s91
    v_mov_b32 v29, s12
    ds_write_b32 v28, v29
    v_mov_b32 v24, 29328
    s_mov_b32 s91, 8000000
L_FW_Q_25:
    ds_read_b128 v[20:23], v24
    s_waitcnt lgkmcnt(0)
    v_xor_b32 v20, s12, v20
    v_bitop3_b32 v20, v20, v21, s12 bitop3:0xf6
    v_bitop3_b32 v20, v20, v22, s12 bitop3:0xf6
    v_bitop3_b32 v20, v20, v23, s12 bitop3:0xf6
    v_cmp_ne_u32 vcc, 0, v20
    s_cbranch_vccz L_FD_Q_26
    s_sub_u32 s91, s91, 1
    s_cmp_lg_u32 s91, 0
    s_cbranch_scc1 L_FW_Q_25
L_FD_Q_26:
    v_lshlrev_b32 v17, 2, v0
    ds_read_b32 v16, v17 offset:26944
    ds_read_b32 v18, v17 offset:27200
    ds_read_b32 v19, v17 offset:27456
    ds_read_b32 v20, v17 offset:27712
    s_waitcnt lgkmcnt(0)
    v_add_f32 v16, v16, v18
    v_add_f32 v19, v19, v20
    v_add_f32 v16, v16, v19
    s_cmp_lg_u32 s3, 0
    s_cbranch_scc1 L_PRE_QG
    s_lshl_b32 s60, s7, 8
    s_add_u32 s60, s60, 32768
    v_lshrrev_b32 v21, 1, v0
    v_lshlrev_b32 v21, 3, v21
    v_mov_b32_dpp v20, v16 quad_perm:[1,1,3,3] row_mask:0xf bank_mask:0xf
    v_cvt_pk_bf16_f32 v26, v16, v20
    s_mov_b32 s56, 0x55555555
    s_mov_b32 s57, 0x55555555
    s_mov_b64 exec, s[56:57]
    buffer_store_dwordx2 v[26:27], v21, s[8:11], s60 offen sc1
    s_mov_b64 exec, -1
    s_branch L_PRE_QG
L_PRE_F:
    s_cmp_eq_u32 s3, 1
    s_cbranch_scc1 L_PRE_NONE
    v_lshrrev_b32 v12, 2, v0
    v_mul_u32_u24 v10, 3456, v12
    v_lshl_add_u32 v10, v6, 4, v10
    s_mul_i32 s56, s3, 552960
    s_lshl_b32 s57, s7, 6
    s_add_u32 s56, s56, s57
    s_mul_i32 s59, s3, 10240
    s_add_u32 s59, s59, 29952
    s_mov_b32 s44, s28
    s_mov_b32 s45, s29
    s_mov_b32 s46, 2211840
    s_mov_b32 s47, 0x20000
    s_mov_b32 s48, s30
    s_mov_b32 s49, s31
    s_mov_b32 s50, 2211840
    s_mov_b32 s51, 0x20000
    s_mov_b32 s57, s56
    s_add_u32 m0, s59, 0
    s_nop 0
    buffer_load_dwordx4 v10, s[44:47], s57 offen nt lds
    s_add_u32 s57, s57, 55296
    s_add_u32 m0, s59, 1024
    s_nop 0
    buffer_load_dwordx4 v10, s[44:47], s57 offen nt lds
    s_add_u32 s57, s57, 55296
    s_add_u32 m0, s59, 2048
    s_nop 0
    buffer_load_dwordx4 v10, s[44:47], s57 offen nt lds
    s_add_u32 s57, s57, 55296
    s_add_u32 m0, s59, 3072
    s_nop 0
    buffer_load_dwordx4 v10, s[44:47], s57 offen nt lds
    s_add_u32 s57, s57, 55296
    s_add_u32 m0, s59, 4096
    s_nop 0
    buffer_load_dwordx4 v10, s[44:47], s57 offen nt lds
    s_add_u32 s57, s57, 55296
    s_add_u32 m0, s59, 5120
    s_nop 0
    buffer_load_dwordx4 v10, s[44:47], s57 offen nt lds
    s_add_u32 s57, s57, 55296
    s_add_u32 m0, s59, 6144
    s_nop 0
    buffer_load_dwordx4 v10, s[44:47], s57 offen nt lds
    s_add_u32 s57, s57, 55296
    s_add_u32 m0, s59, 7168
    s_nop 0
    buffer_load_dwordx4 v10, s[44:47], s57 offen nt lds
    s_add_u32 s57, s57, 55296
    s_add_u32 m0, s59, 8192
    s_nop 0
    buffer_load_dwordx4 v10, s[44:47], s57 offen nt lds
    s_add_u32 s57, s57, 55296
    s_add_u32 m0, s59, 9216
    s_nop 0
    buffer_load_dwordx4 v10, s[44:47], s57 offen nt lds
    s_mov_b32 s57, s56
    s_add_u32 m0, s59, 40960
    s_nop 0
    buffer_load_dwordx4 v10, s[48:51], s57 offen nt lds
    s_add_u32 s57, s57, 55296
    s_add_u32 m0, s59, 41984
    s_nop 0
    buffer_load_dwordx4 v10, s[48:51], s57 offen nt lds
    s_add_u32 s57, s57, 55296
    s_add_u32 m0, s59, 43008
    s_nop 0
    buffer_load_dwordx4 v10, s[48:51], s57 offen nt lds
    s_add_u32 s57, s57, 55296
    s_add_u32 m0, s59, 44032
    s_nop 0
    buffer_load_dwordx4 v10, s[48:51], s57 offen nt lds
    s_add_u32 s57, s57, 55296
    s_add_u32 m0, s59, 45056
    s_nop 0
    buffer_load_dwordx4 v10, s[48:51], s57 offen nt lds
    s_add_u32 s57, s57, 55296
    s_add_u32 m0, s59, 46080
    s_nop 0
    buffer_load_dwordx4 v10, s[48:51], s57 offen nt lds
    s_add_u32 s57, s57, 55296
    s_add_u32 m0, s59, 47104
    s_nop 0
    buffer_load_dwordx4 v10, s[48:51], s57 offen nt lds
    s_add_u32 s57, s57, 55296
    s_add_u32 m0, s59, 48128
    s_nop 0
    buffer_load_dwordx4 v10, s[48:51], s57 offen nt lds
    s_add_u32 s57, s57, 55296
    s_add_u32 m0, s59, 49152
    s_nop 0
    buffer_load_dwordx4 v10, s[48:51], s57 offen nt lds
    s_add_u32 s57, s57, 55296
    s_add_u32 m0, s59, 50176
    s_nop 0
    buffer_load_dwordx4 v10, s[48:51], s57 offen nt lds
    s_branch L_PRE_NONE
L_PRE_W:
    s_cmp_eq_u32 s3, 1
    s_cbranch_scc1 L_PRE_NONE
    v_cmp_le_u32 vcc, 40, v0
    v_subrev_u32 v14, 40, v0
    s_nop 0
    v_cndmask_b32 v13, v0, v14, vcc
    v_lshlrev_b32 v10, 4, v13
    v_add_u32 v15, 1280, v10
    v_cndmask_b32 v10, v10, v15, vcc
    s_mul_i32 s57, s5, 163840
    s_bfe_u32 s58, s4, 0x10001
    s_mul_i32 s58, s58, 640
    s_add_u32 s57, s57, s58
    s_mul_i32 s58, s3, 40960
    s_add_u32 s57, s57, s58
    s_mov_b32 s44, s24
    s_mov_b32 s45, s25
    s_mov_b32 s46, 5242880
    s_mov_b32 s47, 0x20000
    s_add_u32 m0, s52, 0
    s_nop 0
    buffer_load_dwordx4 v10, s[44:47], s57 offen nt lds
    v_add_u32 v13, 24, v13
    v_add_u32 v10, 1664, v10
    v_cmp_le_u32 vcc, 40, v13
    v_subrev_u32 v14, 40, v13
    v_add_u32 v15, 640, v10
    v_cndmask_b32 v13, v13, v14, vcc
    v_cndmask_b32 v10, v10, v15, vcc
    s_add_u32 m0, s52, 1024
    s_nop 0
    buffer_load_dwordx4 v10, s[44:47], s57 offen nt lds
    v_add_u32 v13, 24, v13
    v_add_u32 v10, 1664, v10
    v_cmp_le_u32 vcc, 40, v13
    v_subrev_u32 v14, 40, v13
    v_add_u32 v15, 640, v10
    v_cndmask_b32 v13, v13, v14, vcc
    v_cndmask_b32 v10, v10, v15, vcc
    s_add_u32 m0, s52, 2048
    s_nop 0
    buffer_load_dwordx4 v10, s[44:47], s57 offen nt lds
    v_add_u32 v13, 24, v13
    v_add_u32 v10, 1664, v10
    v_cmp_le_u32 vcc, 40, v13
    v_subrev_u32 v14, 40, v13
    v_add_u32 v15, 640, v10
    v_cndmask_b32 v13, v13, v14, vcc
    v_cndmask_b32 v10, v10, v15, vcc
    s_add_u32 m0, s52, 3072
    s_nop 0
    buffer_load_dwordx4 v10, s[44:47], s57 offen nt lds
    v_add_u32 v13, 24, v13
    v_add_u32 v10, 1664, v10
    v_cmp_le_u32 vcc, 40, v13
    v_subrev_u32 v14, 40, v13
    v_add_u32 v15, 640, v10
    v_cndmask_b32 v13, v13, v14, vcc
    v_cndmask_b32 v10, v10, v15, vcc
    s_add_u32 m0, s52, 4096
    s_nop 0
    buffer_load_dwordx4 v10, s[44:47], s57 offen nt lds
    v_add_u32 v13, 24, v13
    v_add_u32 v10, 1664, v10
    v_cmp_le_u32 vcc, 40, v13
    v_subrev_u32 v14, 40, v13
    v_add_u32 v15, 640, v10
    v_cndmask_b32 v13, v13, v14, vcc
    v_cndmask_b32 v10, v10, v15, vcc
    s_add_u32 m0, s52, 5120
    s_nop 0
    buffer_load_dwordx4 v10, s[44:47], s57 offen nt lds
    v_add_u32 v13, 24, v13
    v_add_u32 v10, 1664, v10
    v_cmp_le_u32 vcc, 40, v13
    v_subrev_u32 v14, 40, v13
    v_add_u32 v15, 640, v10
    v_cndmask_b32 v13, v13, v14, vcc
    v_cndmask_b32 v10, v10, v15, vcc
    s_add_u32 m0, s52, 6144
    s_nop 0
    buffer_load_dwordx4 v10, s[44:47], s57 offen nt lds
    v_add_u32 v13, 24, v13
    v_add_u32 v10, 1664, v10
    v_cmp_le_u32 vcc, 40, v13
    v_subrev_u32 v14, 40, v13
    v_add_u32 v15, 640, v10
    v_cndmask_b32 v13, v13, v14, vcc
    v_cndmask_b32 v10, v10, v15, vcc
    s_add_u32 m0, s52, 7168
    s_nop 0
    buffer_load_dwordx4 v10, s[44:47], s57 offen nt lds
    v_add_u32 v13, 24, v13
    v_add_u32 v10, 1664, v10
    v_cmp_le_u32 vcc, 40, v13
    v_subrev_u32 v14, 40, v13
    v_add_u32 v15, 640, v10
    v_cndmask_b32 v13, v13, v14, vcc
    v_cndmask_b32 v10, v10, v15, vcc
    s_add_u32 m0, s52, 8192
    s_nop 0
    buffer_load_dwordx4 v10, s[44:47], s57 offen nt lds
    v_add_u32 v13, 24, v13
    v_add_u32 v10, 1664, v10
    v_cmp_le_u32 vcc, 40, v13
    v_subrev_u32 v14, 40, v13
    v_add_u32 v15, 640, v10
    v_cndmask_b32 v13, v13, v14, vcc
    v_cndmask_b32 v10, v10, v15, vcc
    s_add_u32 m0, s52, 9216
    s_nop 0
    buffer_load_dwordx4 v10, s[44:47], s57 offen nt lds
    v_add_u32 v13, 24, v13
    v_add_u32 v10, 1664, v10
    v_cmp_le_u32 vcc, 40, v13
    v_subrev_u32 v14, 40, v13
    v_add_u32 v15, 640, v10
    v_cndmask_b32 v13, v13, v14, vcc
    v_cndmask_b32 v10, v10, v15, vcc
    s_add_u32 m0, s52, 10240
    s_nop 0
    buffer_load_dwordx4 v10, s[44:47], s57 offen nt lds
    v_add_u32 v13, 24, v13
    v_add_u32 v10, 1664, v10
    v_cmp_le_u32 vcc, 40, v13
    v_subrev_u32 v14, 40, v13
    v_add_u32 v15, 640, v10
    v_cndmask_b32 v13, v13, v14, vcc
    v_cndmask_b32 v10, v10, v15, vcc
    s_add_u32 m0, s52, 11264
    s_nop 0
    buffer_load_dwordx4 v10, s[44:47], s57 offen nt lds
    v_add_u32 v13, 24, v13
    v_add_u32 v10, 1664, v10
    v_cmp_le_u32 vcc, 40, v13
    v_subrev_u32 v14, 40, v13
    v_add_u32 v15, 640, v10
    v_cndmask_b32 v13, v13, v14, vcc
    v_cndmask_b32 v10, v10, v15, vcc
    s_add_u32 m0, s52, 12288
    s_nop 0
    buffer_load_dwordx4 v10, s[44:47], s57 offen nt lds
    v_add_u32 v13, 24, v13
    v_add_u32 v10, 1664, v10
    v_cmp_le_u32 vcc, 40, v13
    v_subrev_u32 v14, 40, v13
    v_add_u32 v15, 640, v10
    v_cndmask_b32 v13, v13, v14, vcc
    v_cndmask_b32 v10, v10, v15, vcc
    s_add_u32 m0, s52, 13312
    s_nop 0
    buffer_load_dwordx4 v10, s[44:47], s57 offen nt lds
    v_add_u32 v13, 24, v13
    v_add_u32 v10, 1664, v10
    v_cmp_le_u32 vcc, 40, v13
    v_subrev_u32 v14, 40, v13
    v_add_u32 v15, 640, v10
    v_cndmask_b32 v13, v13, v14, vcc
    v_cndmask_b32 v10, v10, v15, vcc
    s_add_u32 m0, s52, 14336
    s_nop 0
    buffer_load_dwordx4 v10, s[44:47], s57 offen nt lds
    v_add_u32 v13, 24, v13
    v_add_u32 v10, 1664, v10
    v_cmp_le_u32 vcc, 40, v13
    v_subrev_u32 v14, 40, v13
    v_add_u32 v15, 640, v10
    v_cndmask_b32 v13, v13, v14, vcc
    v_cndmask_b32 v10, v10, v15, vcc
    s_add_u32 m0, s52, 15360
    s_nop 0
    buffer_load_dwordx4 v10, s[44:47], s57 offen nt lds
    v_add_u32 v13, 24, v13
    v_add_u32 v10, 1664, v10
    v_cmp_le_u32 vcc, 40, v13
    v_subrev_u32 v14, 40, v13
    v_add_u32 v15, 640, v10
    v_cndmask_b32 v13, v13, v14, vcc
    v_cndmask_b32 v10, v10, v15, vcc
    s_add_u32 m0, s52, 16384
    s_nop 0
    buffer_load_dwordx4 v10, s[44:47], s57 offen nt lds
    v_add_u32 v13, 24, v13
    v_add_u32 v10, 1664, v10
    v_cmp_le_u32 vcc, 40, v13
    v_subrev_u32 v14, 40, v13
    v_add_u32 v15, 640, v10
    v_cndmask_b32 v13, v13, v14, vcc
    v_cndmask_b32 v10, v10, v15, vcc
    s_add_u32 m0, s52, 17408
    s_nop 0
    buffer_load_dwordx4 v10, s[44:47], s57 offen nt lds
    v_add_u32 v13, 24, v13
    v_add_u32 v10, 1664, v10
    v_cmp_le_u32 vcc, 40, v13
    v_subrev_u32 v14, 40, v13
    v_add_u32 v15, 640, v10
    v_cndmask_b32 v13, v13, v14, vcc
    v_cndmask_b32 v10, v10, v15, vcc
    s_add_u32 m0, s52, 18432
    s_nop 0
    buffer_load_dwordx4 v10, s[44:47], s57 offen nt lds
    v_add_u32 v13, 24, v13
    v_add_u32 v10, 1664, v10
    v_cmp_le_u32 vcc, 40, v13
    v_subrev_u32 v14, 40, v13
    v_add_u32 v15, 640, v10
    v_cndmask_b32 v13, v13, v14, vcc
    v_cndmask_b32 v10, v10, v15, vcc
    s_add_u32 m0, s52, 19456
    s_nop 0
    buffer_load_dwordx4 v10, s[44:47], s57 offen nt lds
L_PRE_NONE:
    s_waitcnt lgkmcnt(0)
    s_mul_i32 s12, s12, 1664525
    s_add_u32 s12, s12, 1013904223
    v_mov_b32 v27, s12
L_PRE_QG:
    s_cmp_lg_u32 s3, 1
    s_cbranch_scc1 L_H_BAR1
    s_lshl_b32 s62, s5, 9
    s_add_u32 s62, s62, 32768
    v_lshlrev_b32 v11, 3, v0
    s_mov_b32 s90, 1000000
L_POLL_Q_27:
    buffer_load_dwordx2 v[192:193], v11, s[8:11], s62 offen sc1
    s_waitcnt vmcnt(0)
    v_mov_b32 v29, 0
    v_bitop3_b32 v29, v29, v193, s12 bitop3:0xf6
    v_cmp_ne_u32 vcc, 0, v29
    s_cbranch_vccz L_POLLD_Q_28
    s_sleep 2
    s_sub_u32 s90, s90, 1
    s_cmp_lg_u32 s90, 0
    s_cbranch_scc1 L_POLL_Q_27
    s_mov_b32 s92, s40
    s_mov_b32 s93, s41
    s_mov_b32 s94, 256
    s_mov_b32 s95, 0x20000
    v_mov_b32 v28, 2
    v_mov_b32 v29, 8
    buffer_store_dword v28, v29, s[92:95], 0 offen
L_POLLD_Q_28:
    v_lshlrev_b32 v11, 2, v0
    ds_write_b32 v11, v192 offset:16384
    v_mov_b32 v12, 0x51525359
    v_mov_b32 v13, 29424
    ds_write_b32 v13, v12
    s_waitcnt lgkmcnt(0)
L_H_BAR1:
    s_waitcnt lgkmcnt(0)
    s_barrier
    s_setprio 0
    s_cmp_eq_u32 s6, 3
    s_cselect_b32 s64, 1, 0
    s_mov_b32 s65, s7
    s_cmp_eq_u32 s6, 4
    s_cselect_b32 s63, 1, 0
    s_mov_b32 s68, s5
    s_bfe_u32 s69, s4, 0x10001
    s_lshl_b32 s69, s69, 2
    s_add_u32 s69, s69, s3
    s_mov_b32 s67, s7
    s_cmp_lt_u32 s7, 40
    s_cselect_b32 s66, 1, 0
    s_cmp_eq_u32 s6, 2
    s_cselect_b32 s66, s66, 0
    s_cmp_eq_u32 s63, 0
    s_cbranch_scc1 L_SH_NOWO
    s_cmp_lg_u32 s3, 1
    s_cbranch_scc1 L_SH_W1
    v_cmp_le_u32 vcc, 40, v0
    v_subrev_u32 v14, 40, v0
    s_nop 0
    v_cndmask_b32 v13, v0, v14, vcc
    v_lshlrev_b32 v10, 4, v13
    v_add_u32 v15, 1280, v10
    v_cndmask_b32 v10, v10, v15, vcc
    s_mul_i32 s57, s5, 163840
    s_bfe_u32 s58, s4, 0x10001
    s_mul_i32 s58, s58, 640
    s_add_u32 s57, s57, s58
    s_mul_i32 s58, s3, 40960
    s_add_u32 s57, s57, s58
    s_mov_b32 s44, s24
    s_mov_b32 s45, s25
    s_mov_b32 s46, 5242880
    s_mov_b32 s47, 0x20000
    s_add_u32 m0, s52, 0
    s_nop 0
    buffer_load_dwordx4 v10, s[44:47], s57 offen nt lds
    v_add_u32 v13, 24, v13
    v_add_u32 v10, 1664, v10
    v_cmp_le_u32 vcc, 40, v13
    v_subrev_u32 v14, 40, v13
    v_add_u32 v15, 640, v10
    v_cndmask_b32 v13, v13, v14, vcc
    v_cndmask_b32 v10, v10, v15, vcc
    s_add_u32 m0, s52, 1024
    s_nop 0
    buffer_load_dwordx4 v10, s[44:47], s57 offen nt lds
    v_add_u32 v13, 24, v13
    v_add_u32 v10, 1664, v10
    v_cmp_le_u32 vcc, 40, v13
    v_subrev_u32 v14, 40, v13
    v_add_u32 v15, 640, v10
    v_cndmask_b32 v13, v13, v14, vcc
    v_cndmask_b32 v10, v10, v15, vcc
    s_add_u32 m0, s52, 2048
    s_nop 0
    buffer_load_dwordx4 v10, s[44:47], s57 offen nt lds
    v_add_u32 v13, 24, v13
    v_add_u32 v10, 1664, v10
    v_cmp_le_u32 vcc, 40, v13
    v_subrev_u32 v14, 40, v13
    v_add_u32 v15, 640, v10
    v_cndmask_b32 v13, v13, v14, vcc
    v_cndmask_b32 v10, v10, v15, vcc
    s_add_u32 m0, s52, 3072
    s_nop 0
    buffer_load_dwordx4 v10, s[44:47], s57 offen nt lds
    v_add_u32 v13, 24, v13
    v_add_u32 v10, 1664, v10
    v_cmp_le_u32 vcc, 40, v13
    v_subrev_u32 v14, 40, v13
    v_add_u32 v15, 640, v10
    v_cndmask_b32 v13, v13, v14, vcc
    v_cndmask_b32 v10, v10, v15, vcc
    s_add_u32 m0, s52, 4096
    s_nop 0
    buffer_load_dwordx4 v10, s[44:47], s57 offen nt lds
    v_add_u32 v13, 24, v13
    v_add_u32 v10, 1664, v10
    v_cmp_le_u32 vcc, 40, v13
    v_subrev_u32 v14, 40, v13
    v_add_u32 v15, 640, v10
    v_cndmask_b32 v13, v13, v14, vcc
    v_cndmask_b32 v10, v10, v15, vcc
    s_add_u32 m0, s52, 5120
    s_nop 0
    buffer_load_dwordx4 v10, s[44:47], s57 offen nt lds
    v_add_u32 v13, 24, v13
    v_add_u32 v10, 1664, v10
    v_cmp_le_u32 vcc, 40, v13
    v_subrev_u32 v14, 40, v13
    v_add_u32 v15, 640, v10
    v_cndmask_b32 v13, v13, v14, vcc
    v_cndmask_b32 v10, v10, v15, vcc
    s_add_u32 m0, s52, 6144
    s_nop 0
    buffer_load_dwordx4 v10, s[44:47], s57 offen nt lds
    v_add_u32 v13, 24, v13
    v_add_u32 v10, 1664, v10
    v_cmp_le_u32 vcc, 40, v13
    v_subrev_u32 v14, 40, v13
    v_add_u32 v15, 640, v10
    v_cndmask_b32 v13, v13, v14, vcc
    v_cndmask_b32 v10, v10, v15, vcc
    s_add_u32 m0, s52, 7168
    s_nop 0
    buffer_load_dwordx4 v10, s[44:47], s57 offen nt lds
    v_add_u32 v13, 24, v13
    v_add_u32 v10, 1664, v10
    v_cmp_le_u32 vcc, 40, v13
    v_subrev_u32 v14, 40, v13
    v_add_u32 v15, 640, v10
    v_cndmask_b32 v13, v13, v14, vcc
    v_cndmask_b32 v10, v10, v15, vcc
    s_add_u32 m0, s52, 8192
    s_nop 0
    buffer_load_dwordx4 v10, s[44:47], s57 offen nt lds
    v_add_u32 v13, 24, v13
    v_add_u32 v10, 1664, v10
    v_cmp_le_u32 vcc, 40, v13
    v_subrev_u32 v14, 40, v13
    v_add_u32 v15, 640, v10
    v_cndmask_b32 v13, v13, v14, vcc
    v_cndmask_b32 v10, v10, v15, vcc
    s_add_u32 m0, s52, 9216
    s_nop 0
    buffer_load_dwordx4 v10, s[44:47], s57 offen nt lds
    v_add_u32 v13, 24, v13
    v_add_u32 v10, 1664, v10
    v_cmp_le_u32 vcc, 40, v13
    v_subrev_u32 v14, 40, v13
    v_add_u32 v15, 640, v10
    v_cndmask_b32 v13, v13, v14, vcc
    v_cndmask_b32 v10, v10, v15, vcc
    s_add_u32 m0, s52, 10240
    s_nop 0
    buffer_load_dwordx4 v10, s[44:47], s57 offen nt lds
    v_add_u32 v13, 24, v13
    v_add_u32 v10, 1664, v10
    v_cmp_le_u32 vcc, 40, v13
    v_subrev_u32 v14, 40, v13
    v_add_u32 v15, 640, v10
    v_cndmask_b32 v13, v13, v14, vcc
    v_cndmask_b32 v10, v10, v15, vcc
    s_add_u32 m0, s52, 11264
    s_nop 0
    buffer_load_dwordx4 v10, s[44:47], s57 offen nt lds
    v_add_u32 v13, 24, v13
    v_add_u32 v10, 1664, v10
    v_cmp_le_u32 vcc, 40, v13
    v_subrev_u32 v14, 40, v13
    v_add_u32 v15, 640, v10
    v_cndmask_b32 v13, v13, v14, vcc
    v_cndmask_b32 v10, v10, v15, vcc
    s_add_u32 m0, s52, 12288
    s_nop 0
    buffer_load_dwordx4 v10, s[44:47], s57 offen nt lds
    v_add_u32 v13, 24, v13
    v_add_u32 v10, 1664, v10
    v_cmp_le_u32 vcc, 40, v13
    v_subrev_u32 v14, 40, v13
    v_add_u32 v15, 640, v10
    v_cndmask_b32 v13, v13, v14, vcc
    v_cndmask_b32 v10, v10, v15, vcc
    s_add_u32 m0, s52, 13312
    s_nop 0
    buffer_load_dwordx4 v10, s[44:47], s57 offen nt lds
    v_add_u32 v13, 24, v13
    v_add_u32 v10, 1664, v10
    v_cmp_le_u32 vcc, 40, v13
    v_subrev_u32 v14, 40, v13
    v_add_u32 v15, 640, v10
    v_cndmask_b32 v13, v13, v14, vcc
    v_cndmask_b32 v10, v10, v15, vcc
    s_add_u32 m0, s52, 14336
    s_nop 0
    buffer_load_dwordx4 v10, s[44:47], s57 offen nt lds
    v_add_u32 v13, 24, v13
    v_add_u32 v10, 1664, v10
    v_cmp_le_u32 vcc, 40, v13
    v_subrev_u32 v14, 40, v13
    v_add_u32 v15, 640, v10
    v_cndmask_b32 v13, v13, v14, vcc
    v_cndmask_b32 v10, v10, v15, vcc
    s_add_u32 m0, s52, 15360
    s_nop 0
    buffer_load_dwordx4 v10, s[44:47], s57 offen nt lds
    v_add_u32 v13, 24, v13
    v_add_u32 v10, 1664, v10
    v_cmp_le_u32 vcc, 40, v13
    v_subrev_u32 v14, 40, v13
    v_add_u32 v15, 640, v10
    v_cndmask_b32 v13, v13, v14, vcc
    v_cndmask_b32 v10, v10, v15, vcc
    s_add_u32 m0, s52, 16384
    s_nop 0
    buffer_load_dwordx4 v10, s[44:47], s57 offen nt lds
    v_add_u32 v13, 24, v13
    v_add_u32 v10, 1664, v10
    v_cmp_le_u32 vcc, 40, v13
    v_subrev_u32 v14, 40, v13
    v_add_u32 v15, 640, v10
    v_cndmask_b32 v13, v13, v14, vcc
    v_cndmask_b32 v10, v10, v15, vcc
    s_add_u32 m0, s52, 17408
    s_nop 0
    buffer_load_dwordx4 v10, s[44:47], s57 offen nt lds
    v_add_u32 v13, 24, v13
    v_add_u32 v10, 1664, v10
    v_cmp_le_u32 vcc, 40, v13
    v_subrev_u32 v14, 40, v13
    v_add_u32 v15, 640, v10
    v_cndmask_b32 v13, v13, v14, vcc
    v_cndmask_b32 v10, v10, v15, vcc
    s_add_u32 m0, s52, 18432
    s_nop 0
    buffer_load_dwordx4 v10, s[44:47], s57 offen nt lds
    v_add_u32 v13, 24, v13
    v_add_u32 v10, 1664, v10
    v_cmp_le_u32 vcc, 40, v13
    v_subrev_u32 v14, 40, v13
    v_add_u32 v15, 640, v10
    v_cndmask_b32 v13, v13, v14, vcc
    v_cndmask_b32 v10, v10, v15, vcc
    s_add_u32 m0, s52, 19456
    s_nop 0
    buffer_load_dwordx4 v10, s[44:47], s57 offen nt lds
L_SH_W1:
    v_mul_u32_u24 v12, 640, v7
    v_lshl_add_u32 v12, v6, 3, v12
    s_mul_i32 s56, s3, 160
    s_add_u32 s56, s56, 29952
    v_add_u32 v12, s56, v12
    s_waitcnt vmcnt(0)
    s_lshl_b32 s91, s3, 2
    s_add_u32 s91, s91, 29392
    v_mov_b32 v28, s91
    v_mov_b32 v29, s12
    ds_write_b32 v28, v29
    v_mov_b32 v24, 29392
    s_mov_b32 s91, 8000000
L_FW_W1_29:
    ds_read_b128 v[20:23], v24
    s_waitcnt lgkmcnt(0)
    v_xor_b32 v20, s12, v20
    v_bitop3_b32 v20, v20, v21, s12 bitop3:0xf6
    v_bitop3_b32 v20, v20, v22, s12 bitop3:0xf6
    v_bitop3_b32 v20, v20, v23, s12 bitop3:0xf6
    v_cmp_ne_u32 vcc, 0, v20
    s_cbranch_vccz L_FD_W1_30
    s_sleep 4
    s_sub_u32 s91, s91, 1
    s_cmp_lg_u32 s91, 0
    s_cbranch_scc1 L_FW_W1_29
L_FD_W1_30:
    ds_read_b64_tr_b16 v[32:33], v12 offset:0
    ds_read_b64_tr_b16 v[34:35], v12 offset:2560
    ds_read_b64_tr_b16 v[36:37], v12 offset:20480
    ds_read_b64_tr_b16 v[38:39], v12 offset:23040
    ds_read_b64_tr_b16 v[40:41], v12 offset:40960
    ds_read_b64_tr_b16 v[42:43], v12 offset:43520
    ds_read_b64_tr_b16 v[44:45], v12 offset:61440
    ds_read_b64_tr_b16 v[46:47], v12 offset:64000
    ds_read_b64_tr_b16 v[48:49], v12 offset:32
    ds_read_b64_tr_b16 v[50:51], v12 offset:2592
    ds_read_b64_tr_b16 v[52:53], v12 offset:20512
    ds_read_b64_tr_b16 v[54:55], v12 offset:23072
    ds_read_b64_tr_b16 v[56:57], v12 offset:40992
    ds_read_b64_tr_b16 v[58:59], v12 offset:43552
    ds_read_b64_tr_b16 v[60:61], v12 offset:61472
    ds_read_b64_tr_b16 v[62:63], v12 offset:64032
    ds_read_b64_tr_b16 v[64:65], v12 offset:64
    ds_read_b64_tr_b16 v[66:67], v12 offset:2624
    ds_read_b64_tr_b16 v[68:69], v12 offset:20544
    ds_read_b64_tr_b16 v[70:71], v12 offset:23104
    ds_read_b64_tr_b16 v[72:73], v12 offset:41024
    ds_read_b64_tr_b16 v[74:75], v12 offset:43584
    ds_read_b64_tr_b16 v[76:77], v12 offset:61504
    ds_read_b64_tr_b16 v[78:79], v12 offset:64064
    ds_read_b64_tr_b16 v[80:81], v12 offset:96
    ds_read_b64_tr_b16 v[82:83], v12 offset:2656
    ds_read_b64_tr_b16 v[84:85], v12 offset:20576
    ds_read_b64_tr_b16 v[86:87], v12 offset:23136
    ds_read_b64_tr_b16 v[88:89], v12 offset:41056
    ds_read_b64_tr_b16 v[90:91], v12 offset:43616
    ds_read_b64_tr_b16 v[92:93], v12 offset:61536
    ds_read_b64_tr_b16 v[94:95], v12 offset:64096
    ds_read_b64_tr_b16 v[96:97], v12 offset:128
    ds_read_b64_tr_b16 v[98:99], v12 offset:2688
    ds_read_b64_tr_b16 v[100:101], v12 offset:20608
    ds_read_b64_tr_b16 v[102:103], v12 offset:23168
    ds_read_b64_tr_b16 v[104:105], v12 offset:41088
    ds_read_b64_tr_b16 v[106:107], v12 offset:43648
    ds_read_b64_tr_b16 v[108:109], v12 offset:61568
    ds_read_b64_tr_b16 v[110:111], v12 offset:64128
    s_waitcnt lgkmcnt(0)
L_SH_NOWO:
    s_cmp_eq_u32 s64, 0
    s_cbranch_scc1 L_SH_NOF
    s_cmp_lg_u32 s3, 1
    s_cbranch_scc1 L_SH_F1
    v_lshrrev_b32 v12, 2, v0
    v_mul_u32_u24 v10, 3456, v12
    v_lshl_add_u32 v10, v6, 4, v10
    s_mul_i32 s56, s3, 552960
    s_lshl_b32 s57, s7, 6
    s_add_u32 s56, s56, s57
    s_mul_i32 s59, s3, 10240
    s_add_u32 s59, s59, 29952
    s_mov_b32 s44, s28
    s_mov_b32 s45, s29
    s_mov_b32 s46, 2211840
    s_mov_b32 s47, 0x20000
    s_mov_b32 s48, s30
    s_mov_b32 s49, s31
    s_mov_b32 s50, 2211840
    s_mov_b32 s51, 0x20000
    s_mov_b32 s57, s56
    s_add_u32 m0, s59, 0
    s_nop 0
    buffer_load_dwordx4 v10, s[44:47], s57 offen nt lds
    s_add_u32 s57, s57, 55296
    s_add_u32 m0, s59, 1024
    s_nop 0
    buffer_load_dwordx4 v10, s[44:47], s57 offen nt lds
    s_add_u32 s57, s57, 55296
    s_add_u32 m0, s59, 2048
    s_nop 0
    buffer_load_dwordx4 v10, s[44:47], s57 offen nt lds
    s_add_u32 s57, s57, 55296
    s_add_u32 m0, s59, 3072
    s_nop 0
    buffer_load_dwordx4 v10, s[44:47], s57 offen nt lds
    s_add_u32 s57, s57, 55296
    s_add_u32 m0, s59, 4096
    s_nop 0
    buffer_load_dwordx4 v10, s[44:47], s57 offen nt lds
    s_add_u32 s57, s57, 55296
    s_add_u32 m0, s59, 5120
    s_nop 0
    buffer_load_dwordx4 v10, s[44:47], s57 offen nt lds
    s_add_u32 s57, s57, 55296
    s_add_u32 m0, s59, 6144
    s_nop 0
    buffer_load_dwordx4 v10, s[44:47], s57 offen nt lds
    s_add_u32 s57, s57, 55296
    s_add_u32 m0, s59, 7168
    s_nop 0
    buffer_load_dwordx4 v10, s[44:47], s57 offen nt lds
    s_add_u32 s57, s57, 55296
    s_add_u32 m0, s59, 8192
    s_nop 0
    buffer_load_dwordx4 v10, s[44:47], s57 offen nt lds
    s_add_u32 s57, s57, 55296
    s_add_u32 m0, s59, 9216
    s_nop 0
    buffer_load_dwordx4 v10, s[44:47], s57 offen nt lds
    s_mov_b32 s57, s56
    s_add_u32 m0, s59, 40960
    s_nop 0
    buffer_load_dwordx4 v10, s[48:51], s57 offen nt lds
    s_add_u32 s57, s57, 55296
    s_add_u32 m0, s59, 41984
    s_nop 0
    buffer_load_dwordx4 v10, s[48:51], s57 offen nt lds
    s_add_u32 s57, s57, 55296
    s_add_u32 m0, s59, 43008
    s_nop 0
    buffer_load_dwordx4 v10, s[48:51], s57 offen nt lds
    s_add_u32 s57, s57, 55296
    s_add_u32 m0, s59, 44032
    s_nop 0
    buffer_load_dwordx4 v10, s[48:51], s57 offen nt lds
    s_add_u32 s57, s57, 55296
    s_add_u32 m0, s59, 45056
    s_nop 0
    buffer_load_dwordx4 v10, s[48:51], s57 offen nt lds
    s_add_u32 s57, s57, 55296
    s_add_u32 m0, s59, 46080
    s_nop 0
    buffer_load_dwordx4 v10, s[48:51], s57 offen nt lds
    s_add_u32 s57, s57, 55296
    s_add_u32 m0, s59, 47104
    s_nop 0
    buffer_load_dwordx4 v10, s[48:51], s57 offen nt lds
    s_add_u32 s57, s57, 55296
    s_add_u32 m0, s59, 48128
    s_nop 0
    buffer_load_dwordx4 v10, s[48:51], s57 offen nt lds
    s_add_u32 s57, s57, 55296
    s_add_u32 m0, s59, 49152
    s_nop 0
    buffer_load_dwordx4 v10, s[48:51], s57 offen nt lds
    s_add_u32 s57, s57, 55296
    s_add_u32 m0, s59, 50176
    s_nop 0
    buffer_load_dwordx4 v10, s[48:51], s57 offen nt lds
L_SH_F1:
    s_mul_i32 s59, s3, 10240
    s_add_u32 s59, s59, 29952
    v_lshlrev_b32 v12, 6, v7
    v_and_b32 v13, 1, v6
    v_lshl_add_u32 v12, v13, 3, v12
    v_lshrrev_b32 v13, 1, v6
    v_mul_u32_u24 v13, 40960, v13
    s_lshl_b32 s56, s3, 4
    s_add_u32 s56, s56, 29952
    v_add3_u32 v12, v12, v13, s56
    s_waitcnt vmcnt(0)
    s_lshl_b32 s91, s3, 2
    s_add_u32 s91, s91, 29344
    v_mov_b32 v28, s91
    v_mov_b32 v29, s12
    ds_write_b32 v28, v29
    v_mov_b32 v24, 29344
    s_mov_b32 s91, 8000000
L_FW_F1_31:
    ds_read_b128 v[20:23], v24
    s_waitcnt lgkmcnt(0)
    v_xor_b32 v20, s12, v20
    v_bitop3_b32 v20, v20, v21, s12 bitop3:0xf6
    v_bitop3_b32 v20, v20, v22, s12 bitop3:0xf6
    v_bitop3_b32 v20, v20, v23, s12 bitop3:0xf6
    v_cmp_ne_u32 vcc, 0, v20
    s_cbranch_vccz L_FD_F1_32
    s_sleep 4
    s_sub_u32 s91, s91, 1
    s_cmp_lg_u32 s91, 0
    s_cbranch_scc1 L_FW_F1_31
L_FD_F1_32:
    ds_read_b64_tr_b16 v[112:113], v12 offset:0
    ds_read_b64_tr_b16 v[114:115], v12 offset:256
    ds_read_b64_tr_b16 v[116:117], v12 offset:2048
    ds_read_b64_tr_b16 v[118:119], v12 offset:2304
    ds_read_b64_tr_b16 v[120:121], v12 offset:4096
    ds_read_b64_tr_b16 v[122:123], v12 offset:4352
    ds_read_b64_tr_b16 v[124:125], v12 offset:6144
    ds_read_b64_tr_b16 v[126:127], v12 offset:6400
    ds_read_b64_tr_b16 v[128:129], v12 offset:8192
    ds_read_b64_tr_b16 v[130:131], v12 offset:8448
    ds_read_b64_tr_b16 v[132:133], v12 offset:10240
    ds_read_b64_tr_b16 v[134:135], v12 offset:10496
    ds_read_b64_tr_b16 v[136:137], v12 offset:12288
    ds_read_b64_tr_b16 v[138:139], v12 offset:12544
    ds_read_b64_tr_b16 v[140:141], v12 offset:14336
    ds_read_b64_tr_b16 v[142:143], v12 offset:14592
    ds_read_b64_tr_b16 v[144:145], v12 offset:16384
    ds_read_b64_tr_b16 v[146:147], v12 offset:16640
    ds_read_b64_tr_b16 v[148:149], v12 offset:18432
    ds_read_b64_tr_b16 v[150:151], v12 offset:18688
    ds_read_b64_tr_b16 v[152:153], v12 offset:20480
    ds_read_b64_tr_b16 v[154:155], v12 offset:20736
    ds_read_b64_tr_b16 v[156:157], v12 offset:22528
    ds_read_b64_tr_b16 v[158:159], v12 offset:22784
    ds_read_b64_tr_b16 v[160:161], v12 offset:24576
    ds_read_b64_tr_b16 v[162:163], v12 offset:24832
    ds_read_b64_tr_b16 v[164:165], v12 offset:26624
    ds_read_b64_tr_b16 v[166:167], v12 offset:26880
    ds_read_b64_tr_b16 v[168:169], v12 offset:28672
    ds_read_b64_tr_b16 v[170:171], v12 offset:28928
    ds_read_b64_tr_b16 v[172:173], v12 offset:30720
    ds_read_b64_tr_b16 v[174:175], v12 offset:30976
    ds_read_b64_tr_b16 v[176:177], v12 offset:32768
    ds_read_b64_tr_b16 v[178:179], v12 offset:33024
    ds_read_b64_tr_b16 v[180:181], v12 offset:34816
    ds_read_b64_tr_b16 v[182:183], v12 offset:35072
    ds_read_b64_tr_b16 v[184:185], v12 offset:36864
    ds_read_b64_tr_b16 v[186:187], v12 offset:37120
    ds_read_b64_tr_b16 v[188:189], v12 offset:38912
    ds_read_b64_tr_b16 v[190:191], v12 offset:39168
    s_waitcnt lgkmcnt(0)
    s_lshl_b32 s91, s3, 2
    s_add_u32 s91, s91, 29360
    v_mov_b32 v28, s91
    v_mov_b32 v29, s12
    ds_write_b32 v28, v29
    v_mov_b32 v24, 29360
    s_mov_b32 s91, 8000000
L_FW_F2_33:
    ds_read_b128 v[20:23], v24
    s_waitcnt lgkmcnt(0)
    v_xor_b32 v20, s12, v20
    v_bitop3_b32 v20, v20, v21, s12 bitop3:0xf6
    v_bitop3_b32 v20, v20, v22, s12 bitop3:0xf6
    v_bitop3_b32 v20, v20, v23, s12 bitop3:0xf6
    v_cmp_ne_u32 vcc, 0, v20
    s_cbranch_vccz L_FD_F2_34
    s_sleep 4
    s_sub_u32 s91, s91, 1
    s_cmp_lg_u32 s91, 0
    s_cbranch_scc1 L_FW_F2_33
L_FD_F2_34:
    s_mov_b32 s44, s32
    s_mov_b32 s45, s33
    s_mov_b32 s46, 2211840
    s_mov_b32 s47, 0x20000
    v_lshlrev_b32 v10, 4, v0
    s_mul_i32 s57, s65, 40960
    s_mul_i32 s58, s3, 10240
    s_add_u32 s57, s57, s58
    s_add_u32 m0, s59, 0
    s_nop 0
    buffer_load_dwordx4 v10, s[44:47], s57 offen nt lds
    s_add_u32 s57, s57, 1024
    s_add_u32 m0, s59, 1024
    s_nop 0
    buffer_load_dwordx4 v10, s[44:47], s57 offen nt lds
    s_add_u32 s57, s57, 1024
    s_add_u32 m0, s59, 2048
    s_nop 0
    buffer_load_dwordx4 v10, s[44:47], s57 offen nt lds
    s_add_u32 s57, s57, 1024
    s_add_u32 m0, s59, 3072
    s_nop 0
    buffer_load_dwordx4 v10, s[44:47], s57 offen nt lds
    s_add_u32 s57, s57, 1024
    s_add_u32 m0, s59, 4096
    s_nop 0
    buffer_load_dwordx4 v10, s[44:47], s57 offen nt lds
    s_add_u32 s57, s57, 1024
    s_add_u32 m0, s59, 5120
    s_nop 0
    buffer_load_dwordx4 v10, s[44:47], s57 offen nt lds
    s_add_u32 s57, s57, 1024
    s_add_u32 m0, s59, 6144
    s_nop 0
    buffer_load_dwordx4 v10, s[44:47], s57 offen nt lds
    s_add_u32 s57, s57, 1024
    s_add_u32 m0, s59, 7168
    s_nop 0
    buffer_load_dwordx4 v10, s[44:47], s57 offen nt lds
    s_add_u32 s57, s57, 1024
    s_add_u32 m0, s59, 8192
    s_nop 0
    buffer_load_dwordx4 v10, s[44:47], s57 offen nt lds
    s_add_u32 s57, s57, 1024
    s_add_u32 m0, s59, 9216
    s_nop 0
    buffer_load_dwordx4 v10, s[44:47], s57 offen nt lds
    v_mul_u32_u24 v12, 1280, v7
    v_lshl_add_u32 v12, v6, 3, v12
    s_mul_i32 s56, s3, 320
    s_add_u32 s56, s56, 29952
    v_add_u32 v12, s56, v12
    s_waitcnt vmcnt(0)
    s_lshl_b32 s91, s3, 2
    s_add_u32 s91, s91, 29376
    v_mov_b32 v28, s91
    v_mov_b32 v29, s12
    ds_write_b32 v28, v29
    v_mov_b32 v24, 29376
    s_mov_b32 s91, 8000000
L_FW_F3_35:
    ds_read_b128 v[20:23], v24
    s_waitcnt lgkmcnt(0)
    v_xor_b32 v20, s12, v20
    v_bitop3_b32 v20, v20, v21, s12 bitop3:0xf6
    v_bitop3_b32 v20, v20, v22, s12 bitop3:0xf6
    v_bitop3_b32 v20, v20, v23, s12 bitop3:0xf6
    v_cmp_ne_u32 vcc, 0, v20
    s_cbranch_vccz L_FD_F3_36
    s_sleep 4
    s_sub_u32 s91, s91, 1
    s_cmp_lg_u32 s91, 0
    s_cbranch_scc1 L_FW_F3_35
L_FD_F3_36:
    ds_read_b64_tr_b16 v[32:33], v12 offset:0
    ds_read_b64_tr_b16 v[34:35], v12 offset:5120
    ds_read_b64_tr_b16 v[36:37], v12 offset:32
    ds_read_b64_tr_b16 v[38:39], v12 offset:5152
    ds_read_b64_tr_b16 v[40:41], v12 offset:64
    ds_read_b64_tr_b16 v[42:43], v12 offset:5184
    ds_read_b64_tr_b16 v[44:45], v12 offset:96
    ds_read_b64_tr_b16 v[46:47], v12 offset:5216
    ds_read_b64_tr_b16 v[48:49], v12 offset:128
    ds_read_b64_tr_b16 v[50:51], v12 offset:5248
    ds_read_b64_tr_b16 v[52:53], v12 offset:160
    ds_read_b64_tr_b16 v[54:55], v12 offset:5280
    ds_read_b64_tr_b16 v[56:57], v12 offset:192
    ds_read_b64_tr_b16 v[58:59], v12 offset:5312
    ds_read_b64_tr_b16 v[60:61], v12 offset:224
    ds_read_b64_tr_b16 v[62:63], v12 offset:5344
    ds_read_b64_tr_b16 v[64:65], v12 offset:256
    ds_read_b64_tr_b16 v[66:67], v12 offset:5376
    ds_read_b64_tr_b16 v[68:69], v12 offset:288
    ds_read_b64_tr_b16 v[70:71], v12 offset:5408
    s_waitcnt lgkmcnt(0)
    v_lshlrev_b32 v11, 4, v0
    s_lshl_b32 s62, s3, 10
    s_add_u32 s62, s62, 12288
    s_mov_b32 s61, 16384
    s_mov_b32 s90, 1000000
L_POLL_SB_37:
    buffer_load_dwordx4 v[96:99], v11, s[8:11], s62 offen sc1
    buffer_load_dwordx4 v[100:103], v11, s[8:11], s61 offen sc1
    s_waitcnt vmcnt(0)
    v_mov_b32 v29, 0
    v_bitop3_b32 v29, v29, v97, s12 bitop3:0xf6
    v_bitop3_b32 v29, v29, v99, s12 bitop3:0xf6
    v_bitop3_b32 v29, v29, v101, s12 bitop3:0xf6
    v_bitop3_b32 v29, v29, v103, s12 bitop3:0xf6
    v_cmp_ne_u32 vcc, 0, v29
    s_cbranch_vccz L_POLLD_SB_38
    s_sleep 1
    s_sub_u32 s90, s90, 1
    s_cmp_lg_u32 s90, 0
    s_cbranch_scc1 L_POLL_SB_37
    s_mov_b32 s92, s40
    s_mov_b32 s93, s41
    s_mov_b32 s94, 256
    s_mov_b32 s95, 0x20000
    v_mov_b32 v28, 3
    v_mov_b32 v29, 12
    buffer_store_dword v28, v29, s[92:95], 0 offen
L_POLLD_SB_38:
L_SH_NOF:
    s_cmp_eq_u32 s66, 0
    s_cbranch_scc1 L_SH_NOO
    s_cmp_lg_u32 s3, 1
    s_cbranch_scc1 L_SH_NOO
    v_and_b32 v11, 7, v0
    v_lshlrev_b32 v12, 2, v11
    s_lshl_b32 s56, s67, 5
    s_mov_b32 s44, s16
    s_mov_b32 s45, s17
    s_mov_b32 s46, 1280
    s_mov_b32 s47, 0x20000
    buffer_load_dword v236, v12, s[44:47], s56 offen
    v_lshlrev_b32 v12, 3, v11
    s_lshl_b32 s56, s67, 6
    s_add_u32 s62, s56, 20480
    s_add_u32 s61, s56, 24576
    s_mov_b32 s90, 1000000
L_POLL_GA_39:
    buffer_load_dwordx2 v[238:239], v12, s[8:11], s62 offen sc1
    buffer_load_dwordx2 v[240:241], v12, s[8:11], s61 offen sc1
    s_waitcnt vmcnt(0)
    v_mov_b32 v29, 0
    v_bitop3_b32 v29, v29, v239, s12 bitop3:0xf6
    v_bitop3_b32 v29, v29, v241, s12 bitop3:0xf6
    v_cmp_ne_u32 vcc, 0, v29
    s_cbranch_vccz L_POLLD_GA_40
    s_sleep 1
    s_sub_u32 s90, s90, 1
    s_cmp_lg_u32 s90, 0
    s_cbranch_scc1 L_POLL_GA_39
    s_mov_b32 s92, s40
    s_mov_b32 s93, s41
    s_mov_b32 s94, 256
    s_mov_b32 s95, 0x20000
    v_mov_b32 v28, 4
    v_mov_b32 v29, 16
    buffer_store_dword v28, v29, s[92:95], 0 offen
L_POLLD_GA_40:
L_SH_NOO:
L_TAILS:
    s_setprio 1
    s_barrier
    s_cmp_lg_u32 s3, 0
    s_cbranch_scc1 L_T_NOCOMB
    s_lshl_b32 s73, s5, 6
    s_lshl_b32 s74, s4, 3
    s_add_u32 s73, s73, s74
    s_add_u32 s73, s73, 98304
    v_lshlrev_b32 v10, 3, v0
    ds_read_b64 v[192:193], v10 offset:24832
    ds_read_b64 v[194:195], v10 offset:25344
    ds_read_b64 v[196:197], v10 offset:25856
    ds_read_b64 v[198:199], v10 offset:26368
    v_mov_b32 v11, 26880
    ds_read_b128 v[12:15], v11
    ds_read_b128 v[16:19], v11 offset:16
    s_mov_b32 s72, 0x3fb8aa3b
    s_lshl_b32 s56, s5, 3
    s_add_u32 s56, s56, s4
    s_lshl_b32 s56, s56, 11
    s_add_u32 s56, s56, 131072
    v_lshlrev_b32 v10, 4, v0
    v_mov_b32 v25, s12
    v_mov_b32 v11, 0
    s_waitcnt lgkmcnt(0)
    v_max_f32 v20, v12, v14
    v_max3_f32 v20, v20, v16, v18
    v_sub_f32 v12, v12, v20
    v_sub_f32 v14, v14, v20
    v_sub_f32 v16, v16, v20
    v_sub_f32 v18, v18, v20
    v_mul_f32 v12, 0x3fb8aa3b, v12
    v_mul_f32 v14, 0x3fb8aa3b, v14
    v_mul_f32 v16, 0x3fb8aa3b, v16
    v_mul_f32 v18, 0x3fb8aa3b, v18
    v_exp_f32 v12, v12
    v_exp_f32 v14, v14
    v_exp_f32 v16, v16
    v_exp_f32 v18, v18
    v_mul_f32 v21, v12, v13
    v_fmac_f32 v21, v14, v15
    v_fmac_f32 v21, v16, v17
    v_fmac_f32 v21, v18, v19
    v_rcp_f32 v22, v21
    v_log_f32 v23, v21
    v_mul_f32 v24, v12, v192
    v_mul_f32 v26, v12, v193
    v_fmac_f32 v24, v14, v194
    v_fmac_f32 v26, v14, v195
    v_fmac_f32 v24, v16, v196
    v_fmac_f32 v26, v16, v197
    v_fmac_f32 v24, v18, v198
    v_fmac_f32 v26, v18, v199
    v_mul_f32 v24, v24, v22
    v_mul_f32 v26, v26, v22
    v_fma_f32 v20, v20, s72, v23
    v_mov_b32 v21, s12
    buffer_store_dwordx4 v[24:27], v10, s[8:11], s56 offen sc1
    s_mov_b64 exec, 1
    buffer_store_dwordx2 v[20:21], v11, s[8:11], s73 offen sc1
    s_mov_b64 exec, -1
L_T_NOCOMB:
    s_cmp_eq_u32 s63, 0
    s_cbranch_scc1 L_T_NOWO
    s_lshl_b32 s56, s68, 14
    s_add_u32 s56, s56, 131072
    v_lshlrev_b32 v10, 4, v0
    v_and_b32 v11, 7, v0
    v_lshlrev_b32 v11, 11, v11
    s_lshl_b32 s57, s3, 12
    s_add_u32 s57, s56, s57
    s_add_u32 s58, s57, 2048
    s_lshl_b32 s59, s68, 6
    s_add_u32 s59, s59, 98304
    v_and_b32 v11, 7, v0
    v_lshlrev_b32 v11, 3, v11
    s_lshl_b32 s76, s3, 1
    s_add_u32 s77, s76, 1
    s_lshl_b32 s78, s3, 9
    s_add_u32 s78, s78, 29952
    v_lshl_add_u32 v17, v0, 3, s78
    v_lshlrev_b32 v18, 3, v0
    s_mov_b32 s90, 1000000
L_P2_A_41:
    buffer_load_dwordx4 v[192:195], v10, s[8:11], s57 offen sc1
    buffer_load_dwordx4 v[196:199], v10, s[8:11], s58 offen sc1
    buffer_load_dwordx2 v[200:201], v11, s[8:11], s59 offen sc1
    s_waitcnt vmcnt(0)
    v_xor_b32 v29, s12, v193
    v_bitop3_b32 v29, v29, v195, s12 bitop3:0xf6
    v_bitop3_b32 v29, v29, v197, s12 bitop3:0xf6
    v_bitop3_b32 v29, v29, v199, s12 bitop3:0xf6
    v_bitop3_b32 v29, v29, v201, s12 bitop3:0xf6
    v_cmp_ne_u32 vcc, 0, v29
    s_cbranch_vccz L_P2A_A_42
    s_sleep 1
    s_sub_u32 s90, s90, 1
    s_cmp_lg_u32 s90, 0
    s_cbranch_scc1 L_P2_A_41
    s_mov_b32 s92, s40
    s_mov_b32 s93, s41
    s_mov_b32 s94, 256
    s_mov_b32 s95, 0x20000
    v_mov_b32 v28, 5
    v_mov_b32 v29, 20
    buffer_store_dword v28, v29, s[92:95], 0 offen
L_P2A_A_42:
    v_mov_b32 v12, v200
    s_nop 1
    v_max_f32_dpp v12, v12, v12 row_ror:1 row_mask:0xf bank_mask:0xf
    s_nop 1
    v_max_f32_dpp v12, v12, v12 row_ror:2 row_mask:0xf bank_mask:0xf
    s_nop 1
    v_max_f32_dpp v12, v12, v12 row_ror:4 row_mask:0xf bank_mask:0xf
    v_sub_f32 v12, v200, v12
    v_exp_f32 v12, v12
    s_nop 0
    v_mov_b32 v13, v12
    s_nop 1
    v_add_f32_dpp v13, v13, v13 row_ror:1 row_mask:0xf bank_mask:0xf
    s_nop 1
    v_add_f32_dpp v13, v13, v13 row_ror:2 row_mask:0xf bank_mask:0xf
    s_nop 1
    v_add_f32_dpp v13, v13, v13 row_ror:4 row_mask:0xf bank_mask:0xf
    v_rcp_f32 v13, v13
    s_nop 0
    v_mul_f32 v12, v12, v13
    s_nop 0
    v_readlane_b32 s79, v12, s76
    v_readlane_b32 s80, v12, s77
    s_nop 0
    v_mul_f32 v14, s79, v192
    v_mul_f32 v15, s79, v194
    v_fmac_f32 v14, s80, v196
    v_fmac_f32 v15, s80, v198
    ds_write_b64 v17, v[14:15]
    s_waitcnt lgkmcnt(0)
    s_barrier
    ds_read_b64 v[192:193], v18 offset:29952
    ds_read_b64 v[194:195], v18 offset:30464
    ds_read_b64 v[196:197], v18 offset:30976
    ds_read_b64 v[198:199], v18 offset:31488
    s_waitcnt lgkmcnt(0)
    v_add_f32 v14, v192, v194
    v_add_f32 v15, v193, v195
    v_add_f32 v12, v196, v198
    v_add_f32 v13, v197, v199
    v_add_f32 v14, v14, v12
    v_add_f32 v15, v15, v13
    v_cvt_pk_bf16_f32 v14, v14, v15
    ds_write_b32 v3, v14
    s_waitcnt lgkmcnt(0)
    ds_read_b128 v[152:155], v2 offset:0
    ds_read_b128 v[156:159], v2 offset:64
    ds_read_b128 v[160:163], v2 offset:128
    ds_read_b128 v[164:167], v2 offset:192
    v_cmp_eq_u32 s[56:57], 1, v4
    v_cmp_eq_u32 s[58:59], 2, v4
    v_cmp_eq_u32 s[60:61], 3, v4
    v_mov_b32 v25, s12
    s_mul_i32 s62, s69, 5
    s_lshl_b32 s62, s62, 12
    s_lshl_b32 s73, s68, 7
    s_add_u32 s62, s62, s73
    s_add_u32 s62, s62, 655360
    s_add_u32 s73, s62, 16384
    v_and_b32 v11, 15, v0
    v_lshlrev_b32 v11, 3, v11
    v_lshl_add_u32 v12, v4, 12, v11
    s_waitcnt lgkmcnt(3)
    v_mfma_f32_16x16x32_bf16 v[168:171], v[152:155], v[32:35], 0
    v_mfma_f32_16x16x32_bf16 v[172:175], v[152:155], v[48:51], 0
    v_mfma_f32_16x16x32_bf16 v[176:179], v[152:155], v[64:67], 0
    v_mfma_f32_16x16x32_bf16 v[180:183], v[152:155], v[80:83], 0
    v_mfma_f32_16x16x32_bf16 v[184:187], v[152:155], v[96:99], 0
    s_waitcnt lgkmcnt(2)
    v_mfma_f32_16x16x32_bf16 v[168:171], v[156:159], v[36:39], v[168:171]
    v_mfma_f32_16x16x32_bf16 v[172:175], v[156:159], v[52:55], v[172:175]
    v_mfma_f32_16x16x32_bf16 v[176:179], v[156:159], v[68:71], v[176:179]
    v_mfma_f32_16x16x32_bf16 v[180:183], v[156:159], v[84:87], v[180:183]
    v_mfma_f32_16x16x32_bf16 v[184:187], v[156:159], v[100:103], v[184:187]
    s_waitcnt lgkmcnt(1)
    v_mfma_f32_16x16x32_bf16 v[168:171], v[160:163], v[40:43], v[168:171]
    v_mfma_f32_16x16x32_bf16 v[172:175], v[160:163], v[56:59], v[172:175]
    v_mfma_f32_16x16x32_bf16 v[176:179], v[160:163], v[72:75], v[176:179]
    v_mfma_f32_16x16x32_bf16 v[180:183], v[160:163], v[88:91], v[180:183]
    v_mfma_f32_16x16x32_bf16 v[184:187], v[160:163], v[104:107], v[184:187]
    s_waitcnt lgkmcnt(0)
    v_mfma_f32_16x16x32_bf16 v[168:171], v[164:167], v[44:47], v[168:171]
    v_mfma_f32_16x16x32_bf16 v[172:175], v[164:167], v[60:63], v[172:175]
    v_mfma_f32_16x16x32_bf16 v[176:179], v[164:167], v[76:79], v[176:179]
    v_mfma_f32_16x16x32_bf16 v[180:183], v[164:167], v[92:95], v[180:183]
    v_mfma_f32_16x16x32_bf16 v[184:187], v[164:167], v[108:111], v[184:187]
    s_nop 4
    v_cndmask_b32_e64 v24, v168, v172, s[56:57]
    v_cndmask_b32_e64 v24, v24, v176, s[58:59]
    v_cndmask_b32_e64 v24, v24, v180, s[60:61]
    v_mov_b32 v26, v184
    buffer_store_dwordx2 v[24:25], v12, s[8:11], s62 offen sc1
    s_mov_b64 exec, 0xffff
    buffer_store_dwordx2 v[26:27], v11, s[8:11], s73 offen sc1
    s_mov_b64 exec, -1
L_T_NOWO:
    s_cmp_eq_u32 s66, 0
    s_cbranch_scc1 L_T_NOOWN
    s_cmp_lg_u32 s3, 1
    s_cbranch_scc1 L_T_END
    s_lshl_b32 s62, s67, 12
    s_add_u32 s62, s62, 655360
    v_lshlrev_b32 v10, 4, v0
    v_lshlrev_b32 v16, 16, v238
    v_and_b32 v17, 0xffff0000, v238
    v_lshlrev_b32 v18, 16, v236
    v_and_b32 v19, 0xffff0000, v236
    s_mov_b32 s90, 1000000
L_P2_Y_45:
    buffer_load_dwordx4 v[192:195], v10, s[8:11], s62 offen offset:0 sc1
    buffer_load_dwordx4 v[196:199], v10, s[8:11], s62 offen offset:1024 sc1
    buffer_load_dwordx4 v[200:203], v10, s[8:11], s62 offen offset:2048 sc1
    buffer_load_dwordx4 v[204:207], v10, s[8:11], s62 offen offset:3072 sc1
    s_waitcnt vmcnt(0)
    v_xor_b32 v29, s12, v193
    v_bitop3_b32 v29, v29, v195, s12 bitop3:0xf6
    v_bitop3_b32 v29, v29, v197, s12 bitop3:0xf6
    v_bitop3_b32 v29, v29, v199, s12 bitop3:0xf6
    v_bitop3_b32 v29, v29, v201, s12 bitop3:0xf6
    v_bitop3_b32 v29, v29, v203, s12 bitop3:0xf6
    v_bitop3_b32 v29, v29, v205, s12 bitop3:0xf6
    v_bitop3_b32 v29, v29, v207, s12 bitop3:0xf6
    v_cmp_ne_u32 vcc, 0, v29
    s_cbranch_vccz L_P2A_Y_46
    s_sleep 1
    s_sub_u32 s90, s90, 1
    s_cmp_lg_u32 s90, 0
    s_cbranch_scc1 L_P2_Y_45
    s_mov_b32 s92, s40
    s_mov_b32 s93, s41
    s_mov_b32 s94, 256
    s_mov_b32 s95, 0x20000
    v_mov_b32 v28, 6
    v_mov_b32 v29, 24
    buffer_store_dword v28, v29, s[92:95], 0 offen
L_P2A_Y_46:
    v_add_f32 v12, v192, v196
    v_add_f32 v13, v194, v198
    v_add_f32 v12, v12, v200
    v_add_f32 v13, v13, v202
    v_add_f32 v12, v12, v204
    v_add_f32 v13, v13, v206
    s_nop 0
    v_add_f32_dpp v12, v12, v12 row_ror:8 row_mask:0xf bank_mask:0xf
    v_add_f32_dpp v13, v13, v13 row_ror:8 row_mask:0xf bank_mask:0xf
    v_mov_b32 v14, v12
    v_mov_b32 v15, v13
    s_nop 0
    v_permlane16_swap_b32 v12, v14
    v_permlane16_swap_b32 v13, v15
    v_add_f32 v12, v12, v14
    v_add_f32 v13, v13, v15
    v_mov_b32 v14, v12
    v_mov_b32 v15, v13
    s_nop 0
    v_permlane32_swap_b32 v12, v14
    v_permlane32_swap_b32 v13, v15
    v_add_f32 v12, v12, v14
    v_add_f32 v13, v13, v15
    v_cvt_pk_bf16_f32 v12, v12, v12
    v_and_b32 v12, 0xffff0000, v12
    v_mul_f32 v12, v12, v16
    v_cvt_pk_bf16_f32 v12, v12, v12
    v_and_b32 v12, 0xffff0000, v12
    v_add_f32 v12, v12, v18
    v_cvt_pk_bf16_f32 v244, v12, v12
    v_and_b32 v244, 0xffff0000, v244
    v_cvt_pk_bf16_f32 v13, v13, v13
    v_and_b32 v13, 0xffff0000, v13
    v_mul_f32 v13, v13, v17
    v_cvt_pk_bf16_f32 v13, v13, v13
    v_and_b32 v13, 0xffff0000, v13
    v_add_f32 v13, v13, v19
    v_cvt_pk_bf16_f32 v245, v13, v13
    v_and_b32 v245, 0xffff0000, v245
    v_cvt_pk_bf16_f32 v26, v244, v245
    s_lshl_b32 s62, s67, 6
    s_add_u32 s62, s62, 81920
    v_lshlrev_b32 v11, 3, v0
    s_mov_b64 exec, 0xff
    buffer_store_dwordx2 v[26:27], v11, s[8:11], s62 offen sc1
    s_mov_b64 exec, -1
    s_mul_i32 s62, s67, 6912
    s_add_u32 s62, s62, 851968
    s_add_u32 s61, s62, 4096
    s_mov_b32 s74, -1
    s_mov_b32 s75, 0xffff
    v_mov_b32 v216, 0
    v_mov_b32 v218, 0
    v_mov_b32 v56, 0
    v_mov_b32 v58, 0
    v_lshlrev_b32 v16, 16, v240
    v_and_b32 v17, 0xffff0000, v240
    s_mov_b32 s44, s38
    s_mov_b32 s45, s39
    s_mov_b32 s46, 1280
    s_mov_b32 s47, 0x20000
    s_mov_b32 s90, 1000000
L_P2_D_49:
    buffer_load_dwordx4 v[192:195], v10, s[8:11], s62 offen offset:0 sc1
    buffer_load_dwordx4 v[196:199], v10, s[8:11], s62 offen offset:1024 sc1
    buffer_load_dwordx4 v[200:203], v10, s[8:11], s62 offen offset:2048 sc1
    buffer_load_dwordx4 v[204:207], v10, s[8:11], s62 offen offset:3072 sc1
    buffer_load_dwordx4 v[208:211], v10, s[8:11], s61 offen offset:0 sc1
    buffer_load_dwordx4 v[212:215], v10, s[8:11], s61 offen offset:1024 sc1
    s_mov_b64 exec, s[74:75]
    buffer_load_dwordx4 v[216:219], v10, s[8:11], s61 offen offset:2048 sc1
    s_mov_b64 exec, -1
    s_waitcnt vmcnt(0)
    v_xor_b32 v29, s12, v193
    v_bitop3_b32 v29, v29, v195, s12 bitop3:0xf6
    v_bitop3_b32 v29, v29, v197, s12 bitop3:0xf6
    v_bitop3_b32 v29, v29, v199, s12 bitop3:0xf6
    v_bitop3_b32 v29, v29, v201, s12 bitop3:0xf6
    v_bitop3_b32 v29, v29, v203, s12 bitop3:0xf6
    v_bitop3_b32 v29, v29, v205, s12 bitop3:0xf6
    v_bitop3_b32 v29, v29, v207, s12 bitop3:0xf6
    v_bitop3_b32 v29, v29, v209, s12 bitop3:0xf6
    v_bitop3_b32 v29, v29, v211, s12 bitop3:0xf6
    v_bitop3_b32 v29, v29, v213, s12 bitop3:0xf6
    v_bitop3_b32 v29, v29, v215, s12 bitop3:0xf6
    s_mov_b64 exec, s[74:75]
    v_bitop3_b32 v29, v29, v217, s12 bitop3:0xf6
    v_bitop3_b32 v29, v29, v219, s12 bitop3:0xf6
    s_mov_b64 exec, -1
    v_cmp_ne_u32 vcc, 0, v29
    s_cbranch_vccz L_P2A_D_50
    s_sleep 1
    s_sub_u32 s90, s90, 1
    s_cmp_lg_u32 s90, 0
    s_cbranch_scc1 L_P2_D_49
    s_mov_b32 s92, s40
    s_mov_b32 s93, s41
    s_mov_b32 s94, 256
    s_mov_b32 s95, 0x20000
    v_mov_b32 v28, 8
    v_mov_b32 v29, 32
    buffer_store_dword v28, v29, s[92:95], 0 offen
L_P2A_D_50:
    v_add_f32 v12, v192, v196
    v_add_f32 v13, v194, v198
    v_add_f32 v12, v12, v200
    v_add_f32 v13, v13, v202
    v_add_f32 v12, v12, v204
    v_add_f32 v13, v13, v206
    v_add_f32 v12, v12, v208
    v_add_f32 v13, v13, v210
    v_add_f32 v12, v12, v212
    v_add_f32 v13, v13, v214
    v_add_f32 v12, v12, v216
    v_add_f32 v13, v13, v218
    s_nop 0
    v_add_f32_dpp v12, v12, v12 row_ror:8 row_mask:0xf bank_mask:0xf
    v_add_f32_dpp v13, v13, v13 row_ror:8 row_mask:0xf bank_mask:0xf
    v_mov_b32 v14, v12
    v_mov_b32 v15, v13
    s_nop 0
    v_permlane16_swap_b32 v12, v14
    v_permlane16_swap_b32 v13, v15
    v_add_f32 v12, v12, v14
    v_add_f32 v13, v13, v15
    v_mov_b32 v14, v12
    v_mov_b32 v15, v13
    s_nop 0
    v_permlane32_swap_b32 v12, v14
    v_permlane32_swap_b32 v13, v15
    v_add_f32 v12, v12, v14
    v_add_f32 v13, v13, v15
    v_cvt_pk_bf16_f32 v12, v12, v12
    v_and_b32 v12, 0xffff0000, v12
    v_mul_f32 v12, v12, v16
    v_cvt_pk_bf16_f32 v12, v12, v12
    v_and_b32 v12, 0xffff0000, v12
    v_add_f32 v12, v12, v244
    v_cvt_pk_bf16_f32 v13, v13, v13
    v_and_b32 v13, 0xffff0000, v13
    v_mul_f32 v13, v13, v17
    v_cvt_pk_bf16_f32 v13, v13, v13
    v_and_b32 v13, 0xffff0000, v13
    v_add_f32 v13, v13, v245
    v_cvt_pk_bf16_f32 v12, v12, v13
    v_lshlrev_b32 v11, 2, v0
    s_lshl_b32 s56, s67, 5
    s_mov_b64 exec, 0xff
    buffer_store_dword v12, v11, s[44:47], s56 offen
    s_mov_b64 exec, -1
    s_cmp_lg_u32 s67, 0
    s_cbranch_scc1 L_T_END
    v_mov_b32 v12, s12
    v_mov_b32 v11, 0
    s_mov_b64 exec, 1
    buffer_store_dword v12, v11, s[8:11], 0 offen sc1
    s_mov_b64 exec, -1
    s_branch L_T_END
L_T_NOOWN:
    s_cmp_eq_u32 s64, 0
    s_cbranch_scc1 L_T_END
    v_lshlrev_b32 v11, 3, v0
    s_add_u32 s56, s3, 0
    s_and_b32 s56, s56, 3
    s_lshl_b32 s56, s56, 9
    s_add_u32 s76, s56, 81920
    s_add_u32 s56, s3, 1
    s_and_b32 s56, s56, 3
    s_lshl_b32 s56, s56, 9
    s_add_u32 s77, s56, 81920
    s_add_u32 s56, s3, 2
    s_and_b32 s56, s56, 3
    s_lshl_b32 s56, s56, 9
    s_add_u32 s78, s56, 81920
    s_add_u32 s56, s3, 3
    s_and_b32 s56, s56, 3
    s_lshl_b32 s56, s56, 9
    s_add_u32 s79, s56, 81920
    s_mov_b32 s80, 83968
    s_mov_b32 s90, 1000000
L_P2_X1_53:
    buffer_load_dwordx2 v[192:193], v11, s[8:11], s76 offen sc1
    buffer_load_dwordx2 v[194:195], v11, s[8:11], s77 offen sc1
    buffer_load_dwordx2 v[196:197], v11, s[8:11], s78 offen sc1
    buffer_load_dwordx2 v[198:199], v11, s[8:11], s79 offen sc1
    buffer_load_dwordx2 v[200:201], v11, s[8:11], s80 offen sc1
    s_waitcnt vmcnt(0)
    v_xor_b32 v29, s12, v193
    v_bitop3_b32 v29, v29, v195, s12 bitop3:0xf6
    v_bitop3_b32 v29, v29, v197, s12 bitop3:0xf6
    v_bitop3_b32 v29, v29, v199, s12 bitop3:0xf6
    v_bitop3_b32 v29, v29, v201, s12 bitop3:0xf6
    v_cmp_ne_u32 vcc, 0, v29
    s_cbranch_vccz L_P2A_X1_54
    s_sleep 1
    s_sub_u32 s90, s90, 1
    s_cmp_lg_u32 s90, 0
    s_cbranch_scc1 L_P2_X1_53
    s_mov_b32 s92, s40
    s_mov_b32 s93, s41
    s_mov_b32 s94, 256
    s_mov_b32 s95, 0x20000
    v_mov_b32 v28, 7
    v_mov_b32 v29, 28
    buffer_store_dword v28, v29, s[92:95], 0 offen
L_P2A_X1_54:
    v_lshlrev_b32 v76, 16, v192
    v_and_b32 v77, 0xffff0000, v192
    v_lshlrev_b32 v78, 16, v194
    v_and_b32 v79, 0xffff0000, v194
    v_lshlrev_b32 v80, 16, v196
    v_and_b32 v81, 0xffff0000, v196
    v_lshlrev_b32 v82, 16, v198
    v_and_b32 v83, 0xffff0000, v198
    v_lshlrev_b32 v84, 16, v200
    v_and_b32 v85, 0xffff0000, v200
    v_readfirstlane_b32 s60, v76
    s_nop 1
    v_subrev_f32 v12, s60, v76
    v_subrev_f32 v13, s60, v77
    v_add_f32 v20, v12, v13
    v_mul_f32 v22, v12, v12
    v_fmac_f32 v22, v13, v13
    v_subrev_f32 v12, s60, v78
    v_add_f32 v20, v20, v12
    v_fmac_f32 v22, v12, v12
    v_subrev_f32 v12, s60, v79
    v_add_f32 v20, v20, v12
    v_fmac_f32 v22, v12, v12
    v_subrev_f32 v12, s60, v80
    v_add_f32 v20, v20, v12
    v_fmac_f32 v22, v12, v12
    v_subrev_f32 v12, s60, v81
    v_add_f32 v20, v20, v12
    v_fmac_f32 v22, v12, v12
    v_subrev_f32 v12, s60, v82
    v_add_f32 v20, v20, v12
    v_fmac_f32 v22, v12, v12
    v_subrev_f32 v12, s60, v83
    v_add_f32 v20, v20, v12
    v_fmac_f32 v22, v12, v12
    v_subrev_f32 v12, s60, v84
    v_add_f32 v20, v20, v12
    v_fmac_f32 v22, v12, v12
    v_subrev_f32 v12, s60, v85
    v_add_f32 v20, v20, v12
    v_fmac_f32 v22, v12, v12
    s_nop 0
    v_add_f32_dpp v20, v20, v20 row_shr:1 row_mask:0xf bank_mask:0xf
    v_add_f32_dpp v22, v22, v22 row_shr:1 row_mask:0xf bank_mask:0xf
    s_nop 0
    v_add_f32_dpp v20, v20, v20 row_shr:2 row_mask:0xf bank_mask:0xf
    v_add_f32_dpp v22, v22, v22 row_shr:2 row_mask:0xf bank_mask:0xf
    s_nop 0
    v_add_f32_dpp v20, v20, v20 row_shr:4 row_mask:0xf bank_mask:0xf
    v_add_f32_dpp v22, v22, v22 row_shr:4 row_mask:0xf bank_mask:0xf
    s_nop 0
    v_add_f32_dpp v20, v20, v20 row_shr:8 row_mask:0xf bank_mask:0xf
    v_add_f32_dpp v22, v22, v22 row_shr:8 row_mask:0xf bank_mask:0xf
    s_nop 0
    v_add_f32_dpp v20, v20, v20 row_bcast:15 row_mask:0xa bank_mask:0xf
    v_add_f32_dpp v22, v22, v22 row_bcast:15 row_mask:0xa bank_mask:0xf
    s_nop 0
    v_add_f32_dpp v20, v20, v20 row_bcast:31 row_mask:0xc bank_mask:0xf
    v_add_f32_dpp v22, v22, v22 row_bcast:31 row_mask:0xc bank_mask:0xf
    v_readlane_b32 s61, v20, 63
    v_readlane_b32 s71, v22, 63
    v_mov_b32 v20, 0x3acccccd
    v_mul_f32 v12, s61, v20
    v_mul_f32 v22, s71, v20
    v_fma_f32 v22, -v12, v12, v22
    v_max_f32 v22, 0, v22
    v_add_f32 v20, s60, v12
    v_cvt_pk_bf16_f32 v20, v20, v20
    v_and_b32 v20, 0xffff0000, v20
    v_cvt_pk_bf16_f32 v22, v22, v22
    v_and_b32 v22, 0xffff0000, v22
    v_add_f32 v22, 0x3727c5ac, v22
    v_cvt_pk_bf16_f32 v22, v22, v22
    v_and_b32 v22, 0xffff0000, v22
    v_sqrt_f32 v22, v22
    s_nop 0
    v_cvt_pk_bf16_f32 v22, v22, v22
    v_and_b32 v22, 0xffff0000, v22
    v_rcp_f32 v23, v22
    v_mov_b32 v78, v84
    v_mov_b32 v79, v85
    v_sub_f32 v76, v76, v20
    v_cvt_pk_bf16_f32 v76, v76, v76
    v_and_b32 v76, 0xffff0000, v76
    v_mul_f32 v21, v76, v23
    v_fma_f32 v76, -v21, v22, v76
    v_fma_f32 v76, v76, v23, v21
    v_cvt_pk_bf16_f32 v76, v76, v76
    v_and_b32 v76, 0xffff0000, v76
    v_sub_f32 v77, v77, v20
    v_cvt_pk_bf16_f32 v77, v77, v77
    v_and_b32 v77, 0xffff0000, v77
    v_mul_f32 v21, v77, v23
    v_fma_f32 v77, -v21, v22, v77
    v_fma_f32 v77, v77, v23, v21
    v_cvt_pk_bf16_f32 v77, v77, v77
    v_and_b32 v77, 0xffff0000, v77
    v_sub_f32 v78, v78, v20
    v_cvt_pk_bf16_f32 v78, v78, v78
    v_and_b32 v78, 0xffff0000, v78
    v_mul_f32 v21, v78, v23
    v_fma_f32 v78, -v21, v22, v78
    v_fma_f32 v78, v78, v23, v21
    v_cvt_pk_bf16_f32 v78, v78, v78
    v_and_b32 v78, 0xffff0000, v78
    v_sub_f32 v79, v79, v20
    v_cvt_pk_bf16_f32 v79, v79, v79
    v_and_b32 v79, 0xffff0000, v79
    v_mul_f32 v21, v79, v23
    v_fma_f32 v79, -v21, v22, v79
    v_fma_f32 v79, v79, v23, v21
    v_cvt_pk_bf16_f32 v79, v79, v79
    v_and_b32 v79, 0xffff0000, v79
    s_lshl_b32 s56, s3, 8
    s_add_u32 s56, s56, 27968
    v_lshl_add_u32 v11, v0, 2, s56
    v_lshlrev_b32 v12, 16, v98
    v_and_b32 v13, 0xffff0000, v98
    v_lshlrev_b32 v14, 16, v96
    v_and_b32 v15, 0xffff0000, v96
    v_add_f32 v12, 1.0, v12
    v_cvt_pk_bf16_f32 v12, v12, v12
    v_and_b32 v12, 0xffff0000, v12
    v_mul_f32 v12, v76, v12
    v_cvt_pk_bf16_f32 v12, v12, v12
    v_and_b32 v12, 0xffff0000, v12
    v_add_f32 v12, v12, v14
    v_add_f32 v13, 1.0, v13
    v_cvt_pk_bf16_f32 v13, v13, v13
    v_and_b32 v13, 0xffff0000, v13
    v_mul_f32 v13, v77, v13
    v_cvt_pk_bf16_f32 v13, v13, v13
    v_and_b32 v13, 0xffff0000, v13
    v_add_f32 v13, v13, v15
    v_cvt_pk_bf16_f32 v12, v12, v13
    ds_write_b32 v11, v12 offset:0
    v_lshlrev_b32 v11, 2, v0
    s_lshl_b32 s56, s3, 4
    s_mov_b32 s58, s56
    s_mov_b32 s56, 0xffff
    s_mov_b32 s57, 0
    s_lshl_b64 s[56:57], s[56:57], s58
    v_lshlrev_b32 v12, 16, v102
    v_and_b32 v13, 0xffff0000, v102
    v_lshlrev_b32 v14, 16, v100
    v_and_b32 v15, 0xffff0000, v100
    v_add_f32 v12, 1.0, v12
    v_cvt_pk_bf16_f32 v12, v12, v12
    v_and_b32 v12, 0xffff0000, v12
    v_mul_f32 v12, v78, v12
    v_cvt_pk_bf16_f32 v12, v12, v12
    v_and_b32 v12, 0xffff0000, v12
    v_add_f32 v12, v12, v14
    v_add_f32 v13, 1.0, v13
    v_cvt_pk_bf16_f32 v13, v13, v13
    v_and_b32 v13, 0xffff0000, v13
    v_mul_f32 v13, v79, v13
    v_cvt_pk_bf16_f32 v13, v13, v13
    v_and_b32 v13, 0xffff0000, v13
    v_add_f32 v13, v13, v15
    v_cvt_pk_bf16_f32 v12, v12, v13
    s_mov_b64 exec, s[56:57]
    ds_write_b32 v11, v12 offset:28992
    s_mov_b64 exec, -1
    s_waitcnt lgkmcnt(0)
    s_barrier
    s_waitcnt vmcnt(0)
    v_lshlrev_b32 v11, 4, v4
    ds_read_b128 v[192:195], v11 offset:27968
    ds_read_b128 v[196:199], v11 offset:28032
    ds_read_b128 v[200:203], v11 offset:28096
    ds_read_b128 v[204:207], v11 offset:28160
    ds_read_b128 v[208:211], v11 offset:28224
    ds_read_b128 v[212:215], v11 offset:28288
    ds_read_b128 v[216:219], v11 offset:28352
    ds_read_b128 v[220:223], v11 offset:28416
    ds_read_b128 v[224:227], v11 offset:28480
    ds_read_b128 v[228:231], v11 offset:28544
    ds_read_b128 v[232:235], v11 offset:28608
    ds_read_b128 v[236:239], v11 offset:28672
    ds_read_b128 v[240:243], v11 offset:28736
    ds_read_b128 v[244:247], v11 offset:28800
    ds_read_b128 v[248:251], v11 offset:28864
    ds_read_b128 v[252:255], v11 offset:28928
    s_waitcnt lgkmcnt(15)
    v_mfma_f32_16x16x32_bf16 v[16:19], v[192:195], v[112:115], 0
    ds_read_b128 v[192:195], v11 offset:28992
    s_waitcnt lgkmcnt(15)
    v_mfma_f32_16x16x32_bf16 v[16:19], v[196:199], v[116:119], v[16:19]
    ds_read_b128 v[196:199], v11 offset:29056
    s_waitcnt lgkmcnt(15)
    v_mfma_f32_16x16x32_bf16 v[16:19], v[200:203], v[120:123], v[16:19]
    ds_read_b128 v[200:203], v11 offset:29120
    s_waitcnt lgkmcnt(15)
    v_mfma_f32_16x16x32_bf16 v[16:19], v[204:207], v[124:127], v[16:19]
    ds_read_b128 v[204:207], v11 offset:29184
    s_waitcnt lgkmcnt(15)
    v_mfma_f32_16x16x32_bf16 v[16:19], v[208:211], v[128:131], v[16:19]
    s_waitcnt lgkmcnt(14)
    v_mfma_f32_16x16x32_bf16 v[16:19], v[212:215], v[132:135], v[16:19]
    s_waitcnt lgkmcnt(13)
    v_mfma_f32_16x16x32_bf16 v[16:19], v[216:219], v[136:139], v[16:19]
    s_waitcnt lgkmcnt(12)
    v_mfma_f32_16x16x32_bf16 v[16:19], v[220:223], v[140:143], v[16:19]
    s_waitcnt lgkmcnt(11)
    v_mfma_f32_16x16x32_bf16 v[16:19], v[224:227], v[144:147], v[16:19]
    s_waitcnt lgkmcnt(10)
    v_mfma_f32_16x16x32_bf16 v[16:19], v[228:231], v[148:151], v[16:19]
    s_waitcnt lgkmcnt(9)
    v_mfma_f32_16x16x32_bf16 v[16:19], v[232:235], v[152:155], v[16:19]
    s_waitcnt lgkmcnt(8)
    v_mfma_f32_16x16x32_bf16 v[16:19], v[236:239], v[156:159], v[16:19]
    s_waitcnt lgkmcnt(7)
    v_mfma_f32_16x16x32_bf16 v[16:19], v[240:243], v[160:163], v[16:19]
    s_waitcnt lgkmcnt(6)
    v_mfma_f32_16x16x32_bf16 v[16:19], v[244:247], v[164:167], v[16:19]
    s_waitcnt lgkmcnt(5)
    v_mfma_f32_16x16x32_bf16 v[16:19], v[248:251], v[168:171], v[16:19]
    s_waitcnt lgkmcnt(4)
    v_mfma_f32_16x16x32_bf16 v[16:19], v[252:255], v[172:175], v[16:19]
    s_waitcnt lgkmcnt(3)
    v_mfma_f32_16x16x32_bf16 v[16:19], v[192:195], v[176:179], v[16:19]
    s_waitcnt lgkmcnt(2)
    v_mfma_f32_16x16x32_bf16 v[16:19], v[196:199], v[180:183], v[16:19]
    s_waitcnt lgkmcnt(1)
    v_mfma_f32_16x16x32_bf16 v[16:19], v[200:203], v[184:187], v[16:19]
    s_waitcnt lgkmcnt(0)
    v_mfma_f32_16x16x32_bf16 v[16:19], v[204:207], v[188:191], v[16:19]
    s_nop 7
    v_cvt_pk_bf16_f32 v16, v16, v16
    v_and_b32 v16, 0xffff0000, v16
    s_nop 1
    v_mov_b32_dpp v17, v16 row_shl:8 row_mask:0xf bank_mask:0xf
    v_mul_f32 v18, v16, v16
    v_mul_f32 v18, 0x3d372713, v18
    v_fma_f32 v18, v18, v16, v16
    v_mul_f32 v18, 0xc0135761, v18
    v_exp_f32 v18, v18
    s_nop 0
    v_add_f32 v18, 1.0, v18
    v_rcp_f32 v19, v18
    s_nop 0
    v_mul_f32 v20, v16, v19
    v_cvt_pk_bf16_f32 v20, v20, v20
    v_and_b32 v20, 0xffff0000, v20
    v_mul_f32 v20, v20, v17
    v_cvt_pk_bf16_f32 v20, v20, v20
    s_lshl_b32 s56, s3, 4
    s_add_u32 s56, s56, 29248
    v_lshl_add_u32 v21, v0, 1, s56
    s_mov_b64 exec, 0xff
    ds_write_b16 v21, v20
    s_mov_b64 exec, -1
    s_waitcnt lgkmcnt(0)
    s_barrier
    v_lshlrev_b32 v11, 4, v4
    ds_read_b128 v[192:195], v11 offset:29248
    v_cmp_eq_u32 s[56:57], 1, v4
    v_cmp_eq_u32 s[58:59], 2, v4
    v_cmp_eq_u32 s[60:61], 3, v4
    s_mul_i32 s62, s3, 69120
    s_lshl_b32 s76, s65, 7
    s_add_u32 s62, s62, s76
    s_add_u32 s62, s62, 851968
    v_and_b32 v11, 15, v0
    v_lshlrev_b32 v11, 3, v11
    v_mul_u32_u24 v12, 6912, v4
    v_add_u32 v12, v12, v11
    v_mov_b32 v25, s12
    s_waitcnt lgkmcnt(0)
    v_mfma_f32_16x16x32_bf16 v[196:199], v[192:195], v[32:35], 0
    v_mfma_f32_16x16x32_bf16 v[200:203], v[192:195], v[36:39], 0
    v_mfma_f32_16x16x32_bf16 v[204:207], v[192:195], v[40:43], 0
    v_mfma_f32_16x16x32_bf16 v[208:211], v[192:195], v[44:47], 0
    v_mfma_f32_16x16x32_bf16 v[212:215], v[192:195], v[48:51], 0
    v_mfma_f32_16x16x32_bf16 v[216:219], v[192:195], v[52:55], 0
    v_mfma_f32_16x16x32_bf16 v[220:223], v[192:195], v[56:59], 0
    v_mfma_f32_16x16x32_bf16 v[224:227], v[192:195], v[60:63], 0
    v_mfma_f32_16x16x32_bf16 v[228:231], v[192:195], v[64:67], 0
    v_mfma_f32_16x16x32_bf16 v[232:235], v[192:195], v[68:71], 0
    v_cndmask_b32_e64 v20, v196, v200, s[56:57]
    v_cndmask_b32_e64 v20, v20, v204, s[58:59]
    v_cndmask_b32_e64 v20, v20, v208, s[60:61]
    s_nop 0
    v_cndmask_b32_e64 v21, v212, v216, s[56:57]
    v_cndmask_b32_e64 v21, v21, v220, s[58:59]
    v_cndmask_b32_e64 v21, v21, v224, s[60:61]
    s_nop 0
    v_cndmask_b32_e64 v22, v228, v232, s[56:57]
    v_mov_b32_dpp v23, v20 quad_perm:[1,0,3,2] row_mask:0xf bank_mask:0xf
    v_mov_b32_dpp v13, v21 quad_perm:[1,0,3,2] row_mask:0xf bank_mask:0xf
    v_mov_b32_dpp v14, v22 quad_perm:[1,0,3,2] row_mask:0xf bank_mask:0xf
    v_and_b32 v15, 1, v0
    v_cmp_eq_u32 vcc, 1, v15
    s_nop 1
    v_cndmask_b32 v24, v20, v13, vcc
    v_cndmask_b32 v26, v23, v21, vcc
    v_mul_u32_u24 v15, 27648, v15
    v_and_b32 v11, 14, v0
    v_lshlrev_b32 v11, 3, v11
    v_mul_u32_u24 v12, 6912, v4
    v_add3_u32 v12, v12, v11, v15
    buffer_store_dwordx4 v[24:27], v12, s[8:11], s62 offen sc1
    v_mov_b32 v20, v22
    v_mov_b32 v21, s12
    v_mov_b32 v22, v14
    v_mov_b32 v23, s12
    s_add_u32 s62, s62, 55296
    v_mul_u32_u24 v12, 6912, v4
    v_add_u32 v12, v12, v11
    s_mov_b32 s74, 0x55555555
    s_mov_b32 s75, 0
    s_mov_b64 exec, s[74:75]
    buffer_store_dwordx4 v[20:23], v12, s[8:11], s62 offen sc1
    s_mov_b64 exec, -1
L_T_END:
    s_endpgm
L_TAILE:
L_EXIT:
    s_endpgm
KEND:

.section .rodata,"a"
.p2align 6
.amdhsa_kernel adaLN_cond__mha_block_cached__glu_gated_geglu__decode_kernel
  .amdhsa_next_free_vgpr 256
  .amdhsa_next_free_sgpr 102
  .amdhsa_accum_offset 256
  .amdhsa_group_segment_fixed_size 0
  .amdhsa_kernarg_size 112
  .amdhsa_user_sgpr_count 2
  .amdhsa_user_sgpr_kernarg_segment_ptr 1
  .amdhsa_system_sgpr_workgroup_id_x 1
  .amdhsa_float_denorm_mode_32 3
.end_amdhsa_kernel
.text
```
